```python
import torch

def _softmax(x, axis=-1):
    return torch.softmax(x, dim=axis)
def _gelu(x):
    return torch.nn.functional.gelu(x, approximate="tanh")
def _silu(x):
    return torch.nn.functional.silu(x)
def _sigmoid(x):
    return torch.sigmoid(x)
def _layernorm(x, axis=-1, eps=1e-5):
    m = x.mean(dim=axis, keepdim=True)
    v = x.var(dim=axis, keepdim=True, unbiased=False)
    return (x - m) / torch.sqrt(v + eps)
def _scatter_add(tgt, idx, src, axis=0):
    return tgt.clone().index_add_(axis, idx, src)
def _segment_sum(src, seg, n):
    out = torch.zeros((n,) + src.shape[1:], dtype=src.dtype)
    return out.index_add_(0, seg, src)
def _pad(x, pw):
    flat = tuple(v for pair in reversed(pw) for v in pair)
    return torch.nn.functional.pad(x, flat)

kernel_name = 'interleave_layers__sliding_local_dilated__linear_kernel_hedgehog__prompt'

def setup_inputs():

    _w = (lambda a: (lambda t: t.to(torch.bfloat16) if t.is_floating_point() else t)(torch.as_tensor(a)))
    def _A_setup():
        B, S, D = 1, 2048, 448
        return {
            "x": _w((lambda *s: torch.randn(*s, dtype=torch.bfloat16) * 0.05)(B, S, D)),
            "wqkv": _w((lambda *s: torch.randn(*s, dtype=torch.bfloat16) * 0.05)(D, 3 * D)),
            "wo": _w((lambda *s: torch.randn(*s, dtype=torch.bfloat16) * 0.05)(D, D)),
        }
    _A_in = _A_setup()

    def _B_setup():
        B, S, D, H = 1, 2048, 448, 16
        Dh = D // H
        return {
            "x": _w((lambda *s: torch.randn(*s, dtype=torch.bfloat16) * 0.05)(B, S, D)),
            "wqkv": _w((lambda *s: torch.randn(*s, dtype=torch.bfloat16) * 0.4)(D, 3 * D)),
            "w_phi": _w((lambda *s: torch.randn(*s, dtype=torch.bfloat16) * 0.4)(H, Dh, Dh) * (Dh ** -0.5)),
            "wo": _w((lambda *s: torch.randn(*s, dtype=torch.bfloat16) * 0.1)(D, D)),
        }
    _B_in = _B_setup()

    return {
        "A_x": _A_in["x"],
        "A_wqkv": _A_in["wqkv"],
        "A_wo": _A_in["wo"],
        "B_x": _B_in["x"],
        "B_wqkv": _B_in["wqkv"],
        "B_w_phi": _B_in["w_phi"],
        "B_wo": _B_in["wo"],
    }

def reference(A_x, A_wqkv, A_wo, B_x, B_wqkv, B_w_phi, B_wo):
    def _A_ref(x, wqkv, wo):
        B, S, D = x.shape
        H = 16; Dh = D // H
        W, dil = 8, 2
        qkv = (lambda x, *d: x.permute(*d))((x @ wqkv).reshape(B, S, 3, H, Dh), 2, 0, 3, 1, 4)
        q, k, v = qkv[0], qkv[1], qkv[2]
        scale = Dh ** -0.5
        pos = torch.arange(S)
        off = torch.arange(W) * dil
        idx = pos[:, None] - off[None, :]
        mask = idx >= 0
        idx_c = torch.where(mask, idx, 0).reshape(-1)
        kg = k[:, :, idx_c, :].reshape(B, H, S, W, Dh)
        vg = v[:, :, idx_c, :].reshape(B, H, S, W, Dh)
        logits = torch.einsum("bhsd,bhswd->bhsw", q, kg) * scale
        logits = torch.where(mask[None, None, :, :], logits, -1e9)
        attn = _softmax(logits, axis=-1)
        o = torch.einsum("bhsw,bhswd->bhsd", attn, vg)
        return (lambda x, *d: x.permute(*d))(o, 0, 2, 1, 3).reshape(B, S, D) @ wo

    def _B_ref(x, wqkv, w_phi, wo):
        B, S, D = x.shape
        H = 16; Dh = D // H
        qkv = (lambda x, *d: x.permute(*d))((x @ wqkv).reshape(B, S, 3, H, Dh), 2, 0, 3, 1, 4)
        q, k, v = qkv[0], qkv[1], qkv[2]
        pq = torch.einsum("bhsd,hdf->bhsf", q, w_phi)
        pk = torch.einsum("bhsd,hdf->bhsf", k, w_phi)
        phi_q = torch.concatenate([_softmax(pq, axis=-1), _softmax(-pq, axis=-1)], axis=-1)
        phi_k = torch.concatenate([_softmax(pk, axis=-1), _softmax(-pk, axis=-1)], axis=-1)
        kv = torch.einsum("bhsf,bhsd->bhfd", phi_k, v)
        z  = torch.einsum("bhsf->bhf", phi_k)
        num = torch.einsum("bhqf,bhfd->bhqd", phi_q, kv)
        den = torch.einsum("bhqf,bhf->bhq", phi_q, z)[..., None] + 1e-6
        o = num / den
        return (lambda x, *d: x.permute(*d))(o, 0, 2, 1, 3).reshape(B, S, D) @ wo

    x = A_x
    x = x + _A_ref(_layernorm(x, axis=-1), A_wqkv, A_wo)
    x = x + _B_ref(_layernorm(x, axis=-1), B_wqkv, B_w_phi, B_wo)
    x = x + _A_ref(_layernorm(x, axis=-1), A_wqkv, A_wo)
    x = x + _B_ref(_layernorm(x, axis=-1), B_wqkv, B_w_phi, B_wo)
    return x
```

```asm
; @launch grid=(256,1,1) block=(256,1,1) lds=163840
.amdgcn_target "amdgcn-amd-amdhsa--gfx950"
.text
.globl interleave_layers__sliding_local_dilated__linear_kernel_hedgehog__prompt_kernel
.p2align 12
.p2align 8
.type interleave_layers__sliding_local_dilated__linear_kernel_hedgehog__prompt_kernel,@function
interleave_layers__sliding_local_dilated__linear_kernel_hedgehog__prompt_kernel:
    s_load_dwordx4 s[4:7], s[0:1], 0
    s_getpc_b64 s[22:23]
L_pc:
    v_min_u32 v113, 47, v0
    v_lshrrev_b32 v114, 6, v0
    v_lshlrev_b32 v113, 7, v113
    v_readfirstlane_b32 s58, v114
    global_load_dword v245, v113, s[22:23] offset:128
    s_lshr_b32 s89, s2, 8
    s_cbranch_scc1 L_end
    v_and_b32 v0, 63, v0
    s_and_b32 s88, s2, 7
    s_lshr_b32 s89, s2, 7
    s_lshl1_add_u32 s56, s88, s89
    s_lshr_b32 s89, s2, 3
    s_and_b32 s57, s89, 15
    s_and_b32 s59, s89, 7
    s_lshr_b32 s60, s57, 3
    s_lshl1_add_u32 s88, s56, s60
    s_and_b32 s90, s88, 15
    s_lshl_b32 s90, s90, 2
    s_mulk_i32 s90, 28672
    s_lshr_b32 s93, s56, 3
    s_mulk_i32 s93, 7
    s_add_u32 s93, s93, s59
    s_lshl_b32 s93, s93, 7
    s_add_u32 s90, s90, s93
    v_lshrrev_b32 v117, 3, v0
    v_and_b32 v118, 7, v0
    v_mad_u32_u24 v117, v117, 56, 0
    v_lshl_add_u32 v117, v117, 1, v118
    v_lshlrev_b32 v12, 4, v117
    v_add_u32 v119, 13312, v12
    s_mov_b32 s26, 1835008
    s_mov_b32 s27, 0x20000
    s_mov_b32 m0, 151552
    s_mov_b32 s93, s90
    s_cmp_lg_u32 s58, 3
    s_waitcnt lgkmcnt(0)
    s_mov_b64 s[24:25], s[4:5]
    s_cbranch_scc1 L_not3_1
    s_cmp_eq_u32 s59, 7
    s_cbranch_scc1 L_not3_1
    buffer_load_dwordx4 v12, s[24:27], s93 offen lds
    buffer_load_dwordx4 v119, s[24:27], s93 offen offset:1024 lds
    s_addk_i32 m0, 2048
    s_addk_i32 s93, 28672
    buffer_load_dwordx4 v12, s[24:27], s93 offen lds
    buffer_load_dwordx4 v119, s[24:27], s93 offen offset:1024 lds
    s_addk_i32 m0, 2048
    s_addk_i32 s93, 28672
    buffer_load_dwordx4 v12, s[24:27], s93 offen lds
    buffer_load_dwordx4 v119, s[24:27], s93 offen offset:1024 lds
    s_addk_i32 m0, 2048
    s_addk_i32 s93, 28672
    buffer_load_dwordx4 v12, s[24:27], s93 offen lds
    buffer_load_dwordx4 v119, s[24:27], s93 offen offset:1024 lds
L_not3_1:
    s_load_dwordx2 s[8:9], s[0:1], 16
    s_load_dwordx8 s[12:19], s[0:1], 32
    s_load_dwordx2 s[20:21], s[0:1], 72
    s_mov_b32 s28, s6
    s_and_b32 s29, s7, 0xffff
    s_mov_b32 s30, 1204224
    s_mov_b32 s31, 0x20000
    s_lshl2_add_u32 s88, s88, s58
    s_mul_i32 s93, s58, 28672
    s_add_u32 s85, s90, s93
    s_cmp_lg_u32 s58, 3
    s_cbranch_scc1 L_nox0_2
    v_min_u32 v117, 36, v0
    v_lshlrev_b32 v121, 7, v117
    s_mul_i32 s90, s2, 4736
    s_min_u32 s90, s90, 1199488
    buffer_load_dword v245, v121, s[28:31], s90 offen
    s_mul_i32 s90, s89, 1280
    v_min_u32 v112, 9, v0
    v_lshl_add_u32 v112, v112, 7, s90
    v_min_u32 v112, L_end-L_pc, v112
    global_load_dword v245, v112, s[22:23]
L_nox0_2:
    v_and_b32 v115, 15, v0
    v_lshrrev_b32 v116, 4, v0
    v_lshlrev_b32 v1, 4, v0
    v_lshrrev_b32 v117, 2, v0
    v_mul_u32_u24 v118, 2688, v117
    v_lshrrev_b32 v117, 3, v0
    v_and_b32 v117, 2, v117
    v_and_b32 v119, 3, v0
    v_xor_b32 v117, v117, v119
    v_lshl_add_u32 v11, v117, 4, v118
    s_mul_i32 s82, s57, 56
    s_mul_i32 s89, s58, 896
    s_add_u32 s82, s82, s89
    s_mul_i32 s92, s58, 28672
    s_waitcnt lgkmcnt(0)
    s_mov_b32 s48, s20
    s_and_b32 s49, s21, 0xffff
    s_mov_b32 s50, 11534336
    s_mov_b32 s51, 0x20000
    buffer_load_dword v120, off, s[48:51], 0
    s_cmp_eq_u32 s59, 7
    s_cselect_b32 s89, 0, s58
    s_cmp_lg_u32 s89, 3
    s_cbranch_scc1 L_noxt_3
    s_sub_u32 s89, s88, 3
    s_mul_i32 s90, s89, 14336
    s_lshl_b32 s93, s59, 11
    s_add_u32 s90, s90, s93
    s_add_u32 s90, s90, 1048576
    v_mul_u32_u24 v117, 14336, v116
    v_lshl_add_u32 v117, v115, 7, v117
    buffer_load_dword v245, v117, s[48:51], s90 offen
    s_lshl_b32 s89, s89, 10
    s_lshl_b32 s93, s59, 7
    s_add_u32 s89, s89, s93
    s_add_u32 s89, s89, 2883584
    v_lshlrev_b32 v117, 10, v116
    buffer_load_dword v245, v117, s[48:51], s89 offen
    s_sub_u32 s89, s88, 3
    s_lshl_b32 s89, s89, 7
    s_add_u32 s89, s89, 4096
    v_lshlrev_b32 v117, 7, v116
    buffer_load_dword v245, v117, s[48:51], s89 offen
L_noxt_3:
    s_cmp_eq_u32 s58, 3
    s_cbranch_scc1 L_bg_4
    s_add_u32 m0, s92, 0
    s_add_u32 s94, s82, 0
    buffer_load_dwordx4 v11, s[28:31], s94 offen lds
    s_add_u32 m0, s92, 1024
    s_add_u32 s94, s82, 43008
    buffer_load_dwordx4 v11, s[28:31], s94 offen lds
L_bg_4:
    s_mov_b32 s36, s12
    s_and_b32 s37, s13, 0xffff
    s_mov_b32 s38, 1204224
    s_mov_b32 s39, 0x20000
    s_mov_b32 s52, s14
    s_and_b32 s53, s15, 0xffff
    s_mov_b32 s54, 25088
    s_mov_b32 s55, 0x20000
    s_mov_b32 s32, s8
    s_and_b32 s33, s9, 0xffff
    s_mov_b32 s34, 401408
    s_mov_b32 s35, 0x20000
    s_mov_b32 s40, s16
    s_and_b32 s41, s17, 0xffff
    s_mov_b32 s42, 401408
    s_mov_b32 s43, 0x20000
    s_mov_b32 s44, s18
    s_and_b32 s45, s19, 0xffff
    s_mov_b32 s46, 1835008
    s_mov_b32 s47, 0x20000
    s_getreg_b32 s87, hwreg(HW_REG_XCC_ID)
    s_and_b32 s87, s87, 15
    s_lshl_b32 s89, s56, 3
    s_lshl_b32 s90, s58, 1
    s_add_u32 s89, s89, s90
    s_mul_i32 s68, s89, 14336
    s_add_u32 s68, s68, 1048576
    s_lshl_b32 s69, s89, 10
    s_add_u32 s69, s69, 2883584
    s_lshl_b32 s70, s89, 14
    s_add_u32 s70, s70, 3145728
    s_lshl_b32 s91, s89, 7
    s_add_u32 s91, s91, 4096
    s_mul_i32 s71, s88, 14336
    s_lshl_b32 s90, s59, 11
    s_add_u32 s71, s71, s90
    s_add_u32 s71, s71, 1048576
    s_lshl_b32 s72, s88, 10
    s_lshl_b32 s90, s59, 7
    s_add_u32 s72, s72, s90
    s_add_u32 s72, s72, 2883584
    s_lshl_b32 s73, s88, 14
    s_add_u32 s73, s73, 3145728
    s_lshl_b32 s74, s88, 7
    s_lshl_b32 s90, s59, 2
    s_add_u32 s74, s74, s90
    s_add_u32 s74, s74, 4096
    s_lshl_b32 s89, s56, 2
    s_add_u32 s90, s89, s58
    s_lshl_b32 s75, s90, 7
    s_lshl_b32 s90, s57, 2
    s_add_u32 s75, s75, s90
    s_add_u32 s75, s75, 20480
    s_lshr_b32 s90, s88, 1
    s_lshl_b32 s76, s90, 7
    s_add_u32 s76, s76, 20480
    s_lshl_b32 s77, s56, 14
    s_add_u32 s77, s77, 7340032
    s_lshl_b32 s79, s56, 7
    s_add_u32 s79, s79, 65536
    s_and_b32 s89, s56, 7
    s_cmp_eq_u32 s89, 0
    s_cselect_b32 s83, 1, 0
    s_cmp_lg_u32 s89, 7
    s_cselect_b32 s89, 1, 0
    s_and_b32 s90, s88, 7
    s_cmp_eq_u32 s90, 7
    s_cselect_b32 s78, s89, 0
    s_lshl_b32 s89, s57, 2
    s_add_u32 s89, s89, s58
    s_lshl_b32 s81, s89, 14
    s_add_u32 s81, s81, 5242880
    s_bitcmp1_b32 s58, 0
    s_cselect_b32 s89, 13, 16
    s_lshl_b32 s89, s89, 6
    s_lshr_b32 s90, s56, 1
    s_mul_i32 s89, s89, s90
    s_add_u32 s80, s81, s89
    s_mov_b32 s63, 1
    s_mov_b32 s64, 0
    s_mov_b32 s65, 0
    s_mov_b32 s66, 1
    s_mov_b32 s84, 0
    s_mov_b32 s67, 400000
    s_cmp_eq_u32 s58, 3
    s_cbranch_scc1 L_bg_5
    s_add_u32 m0, s92, 2048
    s_add_u32 s94, s82, 86016
    buffer_load_dwordx4 v11, s[28:31], s94 offen lds
    s_add_u32 m0, s92, 3072
    s_add_u32 s94, s82, 129024
    buffer_load_dwordx4 v11, s[28:31], s94 offen lds
L_bg_5:
    v_min_u32 v117, 12, v0
    v_lshlrev_b32 v122, 7, v117
    v_lshlrev_b32 v26, 3, v115
    v_and_b32 v117, 7, v115
    v_lshlrev_b32 v117, 4, v117
    v_lshl_add_u32 v243, v116, 7, v117
    v_lshlrev_b32 v117, 7, v115
    v_lshl_add_u32 v117, v116, 3, v117
    v_add_u32 v123, 151552, v117
    s_mul_i32 s5, s58, 7168
    s_mul_i32 s4, s57, 86016
    s_add_u32 s4, s4, s5
    s_add_u32 s4, s4, 8388608
    s_lshl_b32 s6, s58, 10
    s_add_u32 s6, s6, 86016
    s_min_u32 s89, s59, 6
    s_lshl_b32 s7, s89, 7
    v_mov_b32 v127, v0
    s_cmp_eq_u32 s58, 3
    s_cbranch_scc1 L_s0
L_setup:
    s_cmp_eq_u32 s58, 3
    s_cbranch_scc1 L_bg_6
    s_add_u32 m0, s92, 4096
    s_add_u32 s94, s82, 172032
    buffer_load_dwordx4 v11, s[28:31], s94 offen lds
    s_add_u32 m0, s92, 5120
    s_add_u32 s94, s82, 215040
    buffer_load_dwordx4 v11, s[28:31], s94 offen lds
L_bg_6:
    s_lshl_b32 s89, s58, 11
    v_add_u32 v114, s89, v123
    v_lshrrev_b32 v113, 2, v115
    v_and_b32 v124, 3, v115
    v_lshl_add_u32 v117, v116, 2, v113
    v_lshlrev_b32 v118, 3, v124
    v_lshl_add_u32 v119, v117, 6, v118
    v_and_b32 v125, 1, v116
    v_lshl_add_u32 v2, v125, 5, v119
    v_xor_b32 v3, 32, v2
    s_and_b32 s89, s58, 1
    s_lshr_b32 s90, s58, 1
    s_add_u32 s90, s90, 1
    s_mul_i32 s90, s90, 28672
    s_lshl_b32 s93, s89, 10
    s_add_u32 s90, s90, s93
    v_add_u32 v6, s90, v1
    v_lshl_add_u32 v119, v117, 7, v118
    v_add_u32 v119, 86016, v119
    v_lshrrev_b32 v125, 1, v117
    v_and_b32 v125, 3, v125
    v_xor_b32 v126, 0, v125
    v_lshl_add_u32 v7, v126, 5, v119
    v_xor_b32 v126, 1, v125
    v_lshl_add_u32 v8, v126, 5, v119
    v_xor_b32 v126, 2, v125
    v_lshl_add_u32 v9, v126, 5, v119
    v_xor_b32 v126, 3, v125
    v_lshl_add_u32 v10, v126, 5, v119
    v_lshrrev_b32 v125, 1, v117
    v_xor_b32 v125, v125, v124
    v_and_b32 v125, 3, v125
    v_lshlrev_b32 v125, 4, v125
    v_lshl_add_u32 v126, v117, 6, v125
    s_lshl_b32 s90, s58, 11
    s_add_u32 s93, s90, 123904
    v_add_u32 v18, s93, v126
    s_lshr_b32 s93, s58, 1
    s_lshl_b32 s93, s93, 13
    s_add_u32 s93, s93, 118784
    v_add_u32 v250, s93, v126
    s_lshl_b32 s93, s89, 3
    s_add_u32 s93, s93, 135168
    v_add_u32 v251, s93, v126
    v_lshrrev_b32 v125, 1, v115
    v_xor_b32 v125, v125, v116
    v_and_b32 v125, 3, v125
    v_lshlrev_b32 v125, 4, v125
    v_lshl_add_u32 v126, v115, 6, v125
    v_add_u32 v126, 123904, v126
    v_add_u32 v17, s90, v126
    s_lshl_b32 s93, s58, 10
    v_add_u32 v125, 118784, v1
    v_add_u32 v253, s93, v125
    v_add_u32 v244, s5, v1
    v_add_u32 v240, 57344, v1
    s_cmp_lt_u32 s58, 2
    s_cselect_b64 vcc, -1, 0
    v_cndmask_b32 v126, v126, v125, vcc
    s_lshl_b32 s93, s89, 3
    v_add_u32 v19, s93, v126
    v_lshrrev_b32 v117, 3, v0
    v_and_b32 v119, 4, v117
    v_add_u32 v119, v119, v117
    s_lshr_b32 s93, s58, 1
    s_lshl2_add_u32 s93, s89, s93
    s_lshl_b32 s93, s93, 2
    v_add_u32 v119, s93, v119
    v_mul_u32_u24 v118, 896, v119
    v_and_b32 v117, 6, v117
    v_and_b32 v119, 7, v0
    v_xor_b32 v117, v117, v119
    v_lshl_add_u32 v246, v117, 4, v118
    s_mul_i32 s93, s57, 7
    v_add_u32 v117, s93, v116
    v_and_b32 v119, 1, v117
    v_lshrrev_b32 v117, 1, v117
    v_lshlrev_b32 v117, 8, v117
    v_lshl_add_u32 v117, v119, 3, v117
    v_lshl_add_u32 v4, v115, 4, v117
    v_add_u32 v117, s93, v116
    v_add_u32 v117, 4, v117
    v_and_b32 v119, 1, v117
    v_lshrrev_b32 v117, 1, v117
    v_lshlrev_b32 v117, 8, v117
    v_lshl_add_u32 v117, v119, 3, v117
    v_lshl_add_u32 v5, v115, 4, v117
    v_mov_b32 v118, 2147418112
    v_cmp_gt_u32 vcc, 48, v0
    s_nop 1
    v_cndmask_b32 v5, v118, v5, vcc
    v_cmp_gt_u32 vcc, 48, v0
    s_nop 1
    v_cndmask_b32 v20, 0, -1, vcc
    v_cndmask_b32 v22, 1.0, 0, vcc
    v_mov_b32 v23, 0
    s_cmp_eq_u32 s89, 1
    s_cselect_b64 vcc, -1, 0
    v_cndmask_b32 v31, -1, v20, vcc
    v_lshl_add_u32 v21, v116, 7, v26
    s_cmp_eq_u32 s83, 1
    s_cselect_b64 vcc, -1, 0
    v_cndmask_b32 v24, v1, v118, vcc
    v_cndmask_b32 v25, v21, v118, vcc
    s_lshr_b32 s90, s56, 1
    s_add_u32 s90, s90, 1
    v_add_u32 v117, s90, v115
    v_and_b32 v117, 7, v117
    s_bitcmp1_b32 s58, 0
    s_cselect_b32 s93, 13, 16
    s_lshl_b32 s93, s93, 6
    v_mul_u32_u24 v249, s93, v117
    s_lshr_b32 s93, s93, 2
    v_mul_u32_u24 v117, s93, v116
    v_lshl_add_u32 v117, v115, 4, v117
    s_lshr_b32 s93, s93, 4
    v_cmp_gt_u32 vcc, s93, v115
    s_nop 1
    v_cndmask_b32 v247, v118, v117, vcc
    v_cndmask_b32 v248, 0, -1, vcc
    v_lshlrev_b32 v27, 8, v116
    v_add_u32 v27, 152768, v27
    v_lshlrev_b32 v16, 2, v115
    v_and_b32 v117, 7, v0
    v_min_u32 v117, 6, v117
    v_lshlrev_b32 v127, 2, v117
    v_min_u32 v117, 13, v115
    v_lshlrev_b32 v117, 2, v117
    s_lshl_b32 s93, s57, 7
    s_add_u32 s93, s93, 73728
    v_add_u32 v117, s93, v117
    v_add_u32 v119, s79, v127
    s_cmp_eq_u32 s83, 1
    s_cselect_b32 s93, 0, 16
    v_cmp_gt_u32 vcc, s93, v0
    s_nop 1
    v_cndmask_b32 v252, v117, v119, vcc
    v_cndmask_b32 v28, 0, 16, vcc
    v_cndmask_b32 v13, 16, 0, vcc
    v_lshrrev_b32 v119, 3, v115
    v_lshl_add_u32 v119, v119, 7, v127
    v_add_u32 v119, s91, v119
    s_lshl_b32 s93, s56, 7
    s_add_u32 s93, s93, 69632
    v_lshrrev_b32 v117, 1, v116
    v_lshlrev_b32 v117, 7, v117
    v_xor_b32 v117, s93, v117
    v_add_u32 v117, v117, v16
    v_and_b32 v125, 1, v116
    v_cmp_eq_u32 vcc, 0, v125
    s_nop 1
    v_cndmask_b32 v14, v117, v119, vcc
    v_cndmask_b32 v15, -16, -1, vcc
    v_cndmask_b32 v30, 0, 16, vcc
    v_mov_b32 v117, s87
    v_cndmask_b32 v29, v117, 0, vcc
    v_mov_b32 v125, 0xf149f2ca
    v_lshl_add_u32 v117, v116, 2, 0
    v_sub_u32 v119, v115, v117
    v_cmp_gt_u32 vcc, 8, v119
    s_nop 1
    v_cndmask_b32 v36, v125, 0, vcc
    v_add_u32 v119, 16, v119
    v_cmp_gt_u32 vcc, 8, v119
    s_nop 1
    v_cndmask_b32 v40, v125, 0, vcc
    v_lshl_add_u32 v117, v116, 2, 1
    v_sub_u32 v119, v115, v117
    v_cmp_gt_u32 vcc, 8, v119
    s_nop 1
    v_cndmask_b32 v37, v125, 0, vcc
    v_add_u32 v119, 16, v119
    v_cmp_gt_u32 vcc, 8, v119
    s_nop 1
    v_cndmask_b32 v41, v125, 0, vcc
    v_lshl_add_u32 v117, v116, 2, 2
    v_sub_u32 v119, v115, v117
    v_cmp_gt_u32 vcc, 8, v119
    s_nop 1
    v_cndmask_b32 v38, v125, 0, vcc
    v_add_u32 v119, 16, v119
    v_cmp_gt_u32 vcc, 8, v119
    s_nop 1
    v_cndmask_b32 v42, v125, 0, vcc
    v_lshl_add_u32 v117, v116, 2, 3
    v_sub_u32 v119, v115, v117
    v_cmp_gt_u32 vcc, 8, v119
    s_nop 1
    v_cndmask_b32 v39, v125, 0, vcc
    v_add_u32 v119, 16, v119
    v_cmp_gt_u32 vcc, 8, v119
    s_nop 1
    v_cndmask_b32 v43, v125, 0, vcc
    s_cmp_eq_u32 s58, 0
    s_cselect_b32 s90, s83, 0
    s_cmp_eq_u32 s90, 1
    s_cselect_b64 vcc, -1, 0
    v_cndmask_b32 v44, v40, v125, vcc
    v_cndmask_b32 v45, v41, v125, vcc
    v_cndmask_b32 v46, v42, v125, vcc
    v_cndmask_b32 v47, v43, v125, vcc
    v_mov_b32 v117, 0x3f803f80
    v_accvgpr_write_b32 a232, v117
    v_accvgpr_write_b32 a233, v117
    v_accvgpr_write_b32 a234, v117
    v_accvgpr_write_b32 a235, v117
    v_accvgpr_write_b32 a236, 0
    v_accvgpr_write_b32 a237, 0
    v_accvgpr_write_b32 a240, 0
    v_accvgpr_write_b32 a241, 0
    v_and_b32 v125, 1, v115
    v_lshlrev_b32 v125, 4, v125
    v_mov_b32 v117, 0x3f80
    v_lshlrev_b32 v117, v125, v117
    v_cmp_eq_u32 vcc, v113, v116
    s_nop 1
    v_cndmask_b32 v117, 0, v117, vcc
    v_cmp_gt_u32 vcc, 2, v124
    s_nop 1
    v_cndmask_b32 v119, 0, v117, vcc
    v_cndmask_b32 v117, v117, 0, vcc
    v_accvgpr_write_b32 a238, v119
    v_accvgpr_write_b32 a239, v117
    v_mov_b32 v0, v114
    s_cmp_eq_u32 s58, 3
    s_cbranch_scc1 L_nonce_7
    s_waitcnt vmcnt(6)
    v_readfirstlane_b32 s86, v120
    s_nop 0
    s_add_u32 s89, s86, 0x10100
    s_and_b32 s61, s89, 0xffffff00
    s_and_b32 s62, s89, 0x3fff0000
L_nonce_7:
    v_or_b32 v29, s61, v29
    v_or_b32 v13, s61, v13
    s_cmp_eq_u32 s58, 3
    s_cbranch_scc1 L_walk
    s_add_u32 m0, s92, 6144
    s_add_u32 s94, s82, 258048
    buffer_load_dwordx4 v11, s[28:31], s94 offen lds
    s_add_u32 m0, s92, 7168
    s_add_u32 s94, s82, 301056
    buffer_load_dwordx4 v11, s[28:31], s94 offen lds
    s_barrier
    v_add_u32 v204, s92, v2
    v_add_u32 v205, s92, v3
    v_add_u32 v207, s92, v1
    v_bfe_u32 v206, v1, 4, 5
    v_bfe_u32 v208, v1, 6, 1
    v_lshlrev_b32 v206, 6, v206
    v_lshlrev_b32 v208, 5, v208
    v_xor_b32 v208, 56, v208
    v_add3_u32 v206, v206, v208, s92
    v_mov_b32 v208, 0
    v_mov_b32 v209, 0
    s_add_u32 m0, s92, 8192
    s_add_u32 s94, s82, 344064
    buffer_load_dwordx4 v11, s[28:31], s94 offen lds
    s_add_u32 m0, s92, 9216
    s_add_u32 s94, s82, 387072
    buffer_load_dwordx4 v11, s[28:31], s94 offen lds
    s_add_u32 m0, s92, 10240
    s_add_u32 s94, s82, 430080
    buffer_load_dwordx4 v11, s[28:31], s94 offen lds
    s_add_u32 m0, s92, 11264
    s_add_u32 s94, s82, 473088
    buffer_load_dwordx4 v11, s[28:31], s94 offen lds
    s_add_u32 m0, s92, 12288
    s_add_u32 s94, s82, 516096
    buffer_load_dwordx4 v11, s[28:31], s94 offen lds
    s_add_u32 m0, s92, 13312
    s_add_u32 s94, s82, 559104
    buffer_load_dwordx4 v11, s[28:31], s94 offen lds
    s_barrier
    s_waitcnt vmcnt(12)
    ds_write_b64 v206, v[208:209] offset:0
    ds_read_b64_tr_b16 a[168:169], v204 offset:0
    ds_read_b64_tr_b16 a[170:171], v204 offset:1024
    ds_read_b64_tr_b16 a[172:173], v205 offset:0
    ds_read_b64_tr_b16 a[174:175], v205 offset:1024
    s_add_u32 m0, s92, 14336
    s_add_u32 s94, s82, 602112
    buffer_load_dwordx4 v11, s[28:31], s94 offen lds
    s_add_u32 m0, s92, 15360
    s_add_u32 s94, s82, 645120
    buffer_load_dwordx4 v11, s[28:31], s94 offen lds
    s_waitcnt vmcnt(12)
    ds_write_b64 v206, v[208:209] offset:2048
    ds_read_b64_tr_b16 a[176:177], v204 offset:2048
    ds_read_b64_tr_b16 a[178:179], v204 offset:3072
    ds_read_b64_tr_b16 a[180:181], v205 offset:2048
    ds_read_b64_tr_b16 a[182:183], v205 offset:3072
    s_waitcnt lgkmcnt(7)
    v_mfma_f32_16x16x32_bf16 v[232:235], a[168:171], a[232:235], 0
    s_waitcnt lgkmcnt(5)
    v_mfma_f32_16x16x32_bf16 v[236:239], a[172:175], a[232:235], 0
    ds_write_b128 v207, a[168:171] offset:0
    ds_write_b128 v207, a[172:175] offset:1024
    s_add_u32 m0, s92, 16384
    s_add_u32 s94, s82, 688128
    buffer_load_dwordx4 v11, s[28:31], s94 offen lds
    s_add_u32 m0, s92, 17408
    s_add_u32 s94, s82, 731136
    buffer_load_dwordx4 v11, s[28:31], s94 offen lds
    s_waitcnt vmcnt(12)
    ds_write_b64 v206, v[208:209] offset:4096
    ds_read_b64_tr_b16 a[168:169], v204 offset:4096
    ds_read_b64_tr_b16 a[170:171], v204 offset:5120
    ds_read_b64_tr_b16 a[172:173], v205 offset:4096
    ds_read_b64_tr_b16 a[174:175], v205 offset:5120
    s_waitcnt lgkmcnt(9)
    v_mfma_f32_16x16x32_bf16 v[232:235], a[176:179], a[232:235], v[232:235]
    s_waitcnt lgkmcnt(7)
    v_mfma_f32_16x16x32_bf16 v[236:239], a[180:183], a[232:235], v[236:239]
    ds_write_b128 v207, a[176:179] offset:2048
    ds_write_b128 v207, a[180:183] offset:3072
    s_add_u32 m0, s92, 18432
    s_add_u32 s94, s82, 774144
    buffer_load_dwordx4 v11, s[28:31], s94 offen lds
    s_add_u32 m0, s92, 19456
    s_add_u32 s94, s82, 817152
    buffer_load_dwordx4 v11, s[28:31], s94 offen lds
    s_waitcnt vmcnt(12)
    ds_write_b64 v206, v[208:209] offset:6144
    ds_read_b64_tr_b16 a[176:177], v204 offset:6144
    ds_read_b64_tr_b16 a[178:179], v204 offset:7168
    ds_read_b64_tr_b16 a[180:181], v205 offset:6144
    ds_read_b64_tr_b16 a[182:183], v205 offset:7168
    s_waitcnt lgkmcnt(9)
    v_mfma_f32_16x16x32_bf16 v[232:235], a[168:171], a[232:235], v[232:235]
    s_waitcnt lgkmcnt(7)
    v_mfma_f32_16x16x32_bf16 v[236:239], a[172:175], a[232:235], v[236:239]
    ds_write_b128 v207, a[168:171] offset:4096
    ds_write_b128 v207, a[172:175] offset:5120
    s_add_u32 m0, s92, 20480
    s_add_u32 s94, s82, 860160
    buffer_load_dwordx4 v11, s[28:31], s94 offen lds
    s_add_u32 m0, s92, 21504
    s_add_u32 s94, s82, 903168
    buffer_load_dwordx4 v11, s[28:31], s94 offen lds
    s_waitcnt vmcnt(12)
    ds_write_b64 v206, v[208:209] offset:8192
    ds_read_b64_tr_b16 a[168:169], v204 offset:8192
    ds_read_b64_tr_b16 a[170:171], v204 offset:9216
    ds_read_b64_tr_b16 a[172:173], v205 offset:8192
    ds_read_b64_tr_b16 a[174:175], v205 offset:9216
    s_waitcnt lgkmcnt(9)
    v_mfma_f32_16x16x32_bf16 v[232:235], a[176:179], a[232:235], v[232:235]
    s_waitcnt lgkmcnt(7)
    v_mfma_f32_16x16x32_bf16 v[236:239], a[180:183], a[232:235], v[236:239]
    ds_write_b128 v207, a[176:179] offset:6144
    ds_write_b128 v207, a[180:183] offset:7168
    s_add_u32 m0, s92, 22528
    s_add_u32 s94, s82, 946176
    buffer_load_dwordx4 v11, s[28:31], s94 offen lds
    s_add_u32 m0, s92, 23552
    s_add_u32 s94, s82, 989184
    buffer_load_dwordx4 v11, s[28:31], s94 offen lds
    s_waitcnt vmcnt(12)
    ds_write_b64 v206, v[208:209] offset:10240
    ds_read_b64_tr_b16 a[176:177], v204 offset:10240
    ds_read_b64_tr_b16 a[178:179], v204 offset:11264
    ds_read_b64_tr_b16 a[180:181], v205 offset:10240
    ds_read_b64_tr_b16 a[182:183], v205 offset:11264
    s_waitcnt lgkmcnt(9)
    v_mfma_f32_16x16x32_bf16 v[232:235], a[168:171], a[232:235], v[232:235]
    s_waitcnt lgkmcnt(7)
    v_mfma_f32_16x16x32_bf16 v[236:239], a[172:175], a[232:235], v[236:239]
    ds_write_b128 v207, a[168:171] offset:8192
    ds_write_b128 v207, a[172:175] offset:9216
    s_add_u32 m0, s92, 24576
    s_add_u32 s94, s82, 1032192
    buffer_load_dwordx4 v11, s[28:31], s94 offen lds
    s_add_u32 m0, s92, 25600
    s_add_u32 s94, s82, 1075200
    buffer_load_dwordx4 v11, s[28:31], s94 offen lds
    s_waitcnt vmcnt(12)
    ds_write_b64 v206, v[208:209] offset:12288
    ds_read_b64_tr_b16 a[168:169], v204 offset:12288
    ds_read_b64_tr_b16 a[170:171], v204 offset:13312
    ds_read_b64_tr_b16 a[172:173], v205 offset:12288
    ds_read_b64_tr_b16 a[174:175], v205 offset:13312
    s_waitcnt lgkmcnt(9)
    v_mfma_f32_16x16x32_bf16 v[232:235], a[176:179], a[232:235], v[232:235]
    s_waitcnt lgkmcnt(7)
    v_mfma_f32_16x16x32_bf16 v[236:239], a[180:183], a[232:235], v[236:239]
    ds_write_b128 v207, a[176:179] offset:10240
    ds_write_b128 v207, a[180:183] offset:11264
    s_add_u32 m0, s92, 26624
    s_add_u32 s94, s82, 1118208
    buffer_load_dwordx4 v11, s[28:31], s94 offen lds
    s_add_u32 m0, s92, 27648
    s_add_u32 s94, s82, 1161216
    buffer_load_dwordx4 v11, s[28:31], s94 offen lds
    s_waitcnt vmcnt(12)
    ds_write_b64 v206, v[208:209] offset:14336
    ds_read_b64_tr_b16 a[176:177], v204 offset:14336
    ds_read_b64_tr_b16 a[178:179], v204 offset:15360
    ds_read_b64_tr_b16 a[180:181], v205 offset:14336
    ds_read_b64_tr_b16 a[182:183], v205 offset:15360
    s_waitcnt lgkmcnt(9)
    v_mfma_f32_16x16x32_bf16 v[232:235], a[168:171], a[232:235], v[232:235]
    s_waitcnt lgkmcnt(7)
    v_mfma_f32_16x16x32_bf16 v[236:239], a[172:175], a[232:235], v[236:239]
    ds_write_b128 v207, a[168:171] offset:12288
    ds_write_b128 v207, a[172:175] offset:13312
    s_waitcnt vmcnt(10)
    ds_write_b64 v206, v[208:209] offset:16384
    ds_read_b64_tr_b16 a[168:169], v204 offset:16384
    ds_read_b64_tr_b16 a[170:171], v204 offset:17408
    ds_read_b64_tr_b16 a[172:173], v205 offset:16384
    ds_read_b64_tr_b16 a[174:175], v205 offset:17408
    s_waitcnt lgkmcnt(9)
    v_mfma_f32_16x16x32_bf16 v[232:235], a[176:179], a[232:235], v[232:235]
    s_waitcnt lgkmcnt(7)
    v_mfma_f32_16x16x32_bf16 v[236:239], a[180:183], a[232:235], v[236:239]
    ds_write_b128 v207, a[176:179] offset:14336
    ds_write_b128 v207, a[180:183] offset:15360
    s_waitcnt vmcnt(8)
    ds_write_b64 v206, v[208:209] offset:18432
    ds_read_b64_tr_b16 a[176:177], v204 offset:18432
    ds_read_b64_tr_b16 a[178:179], v204 offset:19456
    ds_read_b64_tr_b16 a[180:181], v205 offset:18432
    ds_read_b64_tr_b16 a[182:183], v205 offset:19456
    s_waitcnt lgkmcnt(9)
    v_mfma_f32_16x16x32_bf16 v[232:235], a[168:171], a[232:235], v[232:235]
    s_waitcnt lgkmcnt(7)
    v_mfma_f32_16x16x32_bf16 v[236:239], a[172:175], a[232:235], v[236:239]
    ds_write_b128 v207, a[168:171] offset:16384
    ds_write_b128 v207, a[172:175] offset:17408
    s_waitcnt vmcnt(6)
    ds_write_b64 v206, v[208:209] offset:20480
    ds_read_b64_tr_b16 a[168:169], v204 offset:20480
    ds_read_b64_tr_b16 a[170:171], v204 offset:21504
    ds_read_b64_tr_b16 a[172:173], v205 offset:20480
    ds_read_b64_tr_b16 a[174:175], v205 offset:21504
    s_waitcnt lgkmcnt(9)
    v_mfma_f32_16x16x32_bf16 v[232:235], a[176:179], a[232:235], v[232:235]
    s_waitcnt lgkmcnt(7)
    v_mfma_f32_16x16x32_bf16 v[236:239], a[180:183], a[232:235], v[236:239]
    ds_write_b128 v207, a[176:179] offset:18432
    ds_write_b128 v207, a[180:183] offset:19456
    s_waitcnt vmcnt(4)
    ds_write_b64 v206, v[208:209] offset:22528
    ds_read_b64_tr_b16 a[176:177], v204 offset:22528
    ds_read_b64_tr_b16 a[178:179], v204 offset:23552
    ds_read_b64_tr_b16 a[180:181], v205 offset:22528
    ds_read_b64_tr_b16 a[182:183], v205 offset:23552
    s_waitcnt lgkmcnt(9)
    v_mfma_f32_16x16x32_bf16 v[232:235], a[168:171], a[232:235], v[232:235]
    s_waitcnt lgkmcnt(7)
    v_mfma_f32_16x16x32_bf16 v[236:239], a[172:175], a[232:235], v[236:239]
    ds_write_b128 v207, a[168:171] offset:20480
    ds_write_b128 v207, a[172:175] offset:21504
    s_waitcnt vmcnt(2)
    ds_write_b64 v206, v[208:209] offset:24576
    ds_read_b64_tr_b16 a[168:169], v204 offset:24576
    ds_read_b64_tr_b16 a[170:171], v204 offset:25600
    ds_read_b64_tr_b16 a[172:173], v205 offset:24576
    ds_read_b64_tr_b16 a[174:175], v205 offset:25600
    s_waitcnt lgkmcnt(9)
    v_mfma_f32_16x16x32_bf16 v[232:235], a[176:179], a[232:235], v[232:235]
    s_waitcnt lgkmcnt(7)
    v_mfma_f32_16x16x32_bf16 v[236:239], a[180:183], a[232:235], v[236:239]
    ds_write_b128 v207, a[176:179] offset:22528
    ds_write_b128 v207, a[180:183] offset:23552
    s_waitcnt vmcnt(0)
    ds_write_b64 v206, v[208:209] offset:26624
    ds_read_b64_tr_b16 a[176:177], v204 offset:26624
    ds_read_b64_tr_b16 a[178:179], v204 offset:27648
    ds_read_b64_tr_b16 a[180:181], v205 offset:26624
    ds_read_b64_tr_b16 a[182:183], v205 offset:27648
    s_waitcnt lgkmcnt(9)
    v_mfma_f32_16x16x32_bf16 v[232:235], a[168:171], a[232:235], v[232:235]
    s_waitcnt lgkmcnt(7)
    v_mfma_f32_16x16x32_bf16 v[236:239], a[172:175], a[232:235], v[236:239]
    ds_write_b128 v207, a[168:171] offset:24576
    ds_write_b128 v207, a[172:175] offset:25600
    s_waitcnt lgkmcnt(4)
    v_mfma_f32_16x16x32_bf16 v[232:235], a[176:179], a[232:235], v[232:235]
    s_waitcnt lgkmcnt(2)
    v_mfma_f32_16x16x32_bf16 v[236:239], a[180:183], a[232:235], v[236:239]
    ds_write_b128 v207, a[176:179] offset:26624
    ds_write_b128 v207, a[180:183] offset:27648
    v_lshrrev_b32 v204, 8, v1
    v_lshlrev_b32 v204, 4, v204
    s_lshl_b32 s88, s58, 7
    s_add_u32 s88, s88, 161792
    v_add_u32 v204, s88, v204
    s_mov_b32 s96, 0x00010001
    s_mov_b32 s97, 0x00010001
    s_mov_b64 exec, s[96:97]
    ds_write_b128 v204, v[232:235]
    ds_write_b128 v204, v[236:239] offset:64
    s_mov_b64 exec, -1
    s_waitcnt lgkmcnt(0)
    s_branch L_qa1
L_s0:
    s_cmp_eq_u32 s59, 7
    s_cbranch_scc1 L_idle_8
    s_waitcnt vmcnt(6)
    ds_read_b64 v[128:129], v123 offset:0
    ds_read_b64 v[130:131], v123 offset:32
    ds_read_b64 v[132:133], v123 offset:64
    ds_read_b64 v[134:135], v123 offset:96
    ds_read_b64 v[136:137], v123 offset:2048
    ds_read_b64 v[138:139], v123 offset:2080
    ds_read_b64 v[140:141], v123 offset:2112
    ds_read_b64 v[142:143], v123 offset:2144
    ds_read_b64 v[144:145], v123 offset:4096
    ds_read_b64 v[146:147], v123 offset:4128
    ds_read_b64 v[148:149], v123 offset:4160
    ds_read_b64 v[150:151], v123 offset:4192
    ds_read_b64 v[152:153], v123 offset:6144
    ds_read_b64 v[154:155], v123 offset:6176
    ds_read_b64 v[156:157], v123 offset:6208
    s_waitcnt lgkmcnt(14)
    ds_read_b64 v[158:159], v123 offset:6240
    v_mov_b32 v125, 0x3f803f80
    s_sub_u32 s93, s71, 43008
    s_sub_u32 s94, s72, 3072
    v_dot2_f32_bf16 v160, v128, v125, 0
    v_dot2_f32_bf16 v161, v128, v128, 0
    s_waitcnt lgkmcnt(11)
    v_dot2_f32_bf16 v162, v136, v125, 0
    v_dot2_f32_bf16 v163, v136, v136, 0
    s_waitcnt lgkmcnt(7)
    v_dot2_f32_bf16 v164, v144, v125, 0
    v_dot2_f32_bf16 v165, v144, v144, 0
    s_waitcnt lgkmcnt(3)
    v_dot2_f32_bf16 v166, v152, v125, 0
    v_dot2_f32_bf16 v167, v152, v152, 0
    v_dot2_f32_bf16 v160, v129, v125, v160
    v_dot2_f32_bf16 v161, v129, v129, v161
    v_dot2_f32_bf16 v162, v137, v125, v162
    v_dot2_f32_bf16 v163, v137, v137, v163
    v_dot2_f32_bf16 v164, v145, v125, v164
    v_dot2_f32_bf16 v165, v145, v145, v165
    v_dot2_f32_bf16 v166, v153, v125, v166
    v_dot2_f32_bf16 v167, v153, v153, v167
    v_dot2_f32_bf16 v160, v130, v125, v160
    v_dot2_f32_bf16 v161, v130, v130, v161
    v_dot2_f32_bf16 v162, v138, v125, v162
    v_dot2_f32_bf16 v163, v138, v138, v163
    v_dot2_f32_bf16 v164, v146, v125, v164
    v_dot2_f32_bf16 v165, v146, v146, v165
    s_waitcnt lgkmcnt(2)
    v_dot2_f32_bf16 v166, v154, v125, v166
    v_dot2_f32_bf16 v167, v154, v154, v167
    v_dot2_f32_bf16 v160, v131, v125, v160
    v_dot2_f32_bf16 v161, v131, v131, v161
    v_dot2_f32_bf16 v162, v139, v125, v162
    v_dot2_f32_bf16 v163, v139, v139, v163
    v_dot2_f32_bf16 v164, v147, v125, v164
    v_dot2_f32_bf16 v165, v147, v147, v165
    v_dot2_f32_bf16 v166, v155, v125, v166
    v_dot2_f32_bf16 v167, v155, v155, v167
    v_dot2_f32_bf16 v160, v132, v125, v160
    v_dot2_f32_bf16 v161, v132, v132, v161
    v_dot2_f32_bf16 v162, v140, v125, v162
    v_dot2_f32_bf16 v163, v140, v140, v163
    v_dot2_f32_bf16 v164, v148, v125, v164
    v_dot2_f32_bf16 v165, v148, v148, v165
    s_waitcnt lgkmcnt(1)
    v_dot2_f32_bf16 v166, v156, v125, v166
    v_dot2_f32_bf16 v167, v156, v156, v167
    v_dot2_f32_bf16 v160, v133, v125, v160
    v_dot2_f32_bf16 v161, v133, v133, v161
    v_dot2_f32_bf16 v162, v141, v125, v162
    v_dot2_f32_bf16 v163, v141, v141, v163
    v_dot2_f32_bf16 v164, v149, v125, v164
    v_dot2_f32_bf16 v165, v149, v149, v165
    v_dot2_f32_bf16 v166, v157, v125, v166
    v_dot2_f32_bf16 v167, v157, v157, v167
    v_dot2_f32_bf16 v160, v134, v125, v160
    v_dot2_f32_bf16 v161, v134, v134, v161
    v_dot2_f32_bf16 v162, v142, v125, v162
    v_dot2_f32_bf16 v163, v142, v142, v163
    v_dot2_f32_bf16 v164, v150, v125, v164
    v_dot2_f32_bf16 v165, v150, v150, v165
    s_waitcnt lgkmcnt(0)
    v_dot2_f32_bf16 v166, v158, v125, v166
    v_dot2_f32_bf16 v167, v158, v158, v167
    v_dot2_f32_bf16 v160, v135, v125, v160
    v_dot2_f32_bf16 v161, v135, v135, v161
    v_dot2_f32_bf16 v162, v143, v125, v162
    v_dot2_f32_bf16 v163, v143, v143, v163
    v_dot2_f32_bf16 v164, v151, v125, v164
    v_dot2_f32_bf16 v165, v151, v151, v165
    v_dot2_f32_bf16 v166, v159, v125, v166
    v_dot2_f32_bf16 v167, v159, v159, v167
    v_permlane32_swap_b32 v160, v161
    v_permlane32_swap_b32 v162, v163
    v_permlane32_swap_b32 v164, v165
    v_permlane32_swap_b32 v166, v167
    v_add_f32 v160, v160, v161
    v_add_f32 v162, v162, v163
    v_add_f32 v164, v164, v165
    v_add_f32 v166, v166, v167
    v_mov_b32 v161, v160
    v_mov_b32 v163, v162
    v_mov_b32 v165, v164
    v_mov_b32 v167, v166
    v_permlane16_swap_b32 v160, v161
    v_permlane16_swap_b32 v162, v163
    v_permlane16_swap_b32 v164, v165
    v_permlane16_swap_b32 v166, v167
    v_add_f32 v160, v160, v161
    v_add_f32 v162, v162, v163
    v_add_f32 v164, v164, v165
    v_add_f32 v166, v166, v167
    v_mov_b32 v161, v160
    v_mov_b32 v163, v162
    v_mov_b32 v165, v164
    v_mov_b32 v167, v166
    v_permlane32_swap_b32 v160, v161
    v_permlane32_swap_b32 v162, v163
    v_permlane32_swap_b32 v164, v165
    v_permlane32_swap_b32 v166, v167
    s_waitcnt vmcnt(0)
    buffer_store_dwordx4 v[128:131], v1, s[48:51], s93 offen
    buffer_store_dwordx4 v[132:135], v1, s[48:51], s93 offen offset:1024
    s_add_u32 s93, s93, 14336
    buffer_store_dwordx4 v[136:139], v1, s[48:51], s93 offen
    buffer_store_dwordx4 v[140:143], v1, s[48:51], s93 offen offset:1024
    s_add_u32 s93, s93, 14336
    buffer_store_dwordx4 v[144:147], v1, s[48:51], s93 offen
    buffer_store_dwordx4 v[148:151], v1, s[48:51], s93 offen offset:1024
    s_add_u32 s93, s93, 14336
    buffer_store_dwordx4 v[152:155], v1, s[48:51], s93 offen
    buffer_store_dwordx4 v[156:159], v1, s[48:51], s93 offen offset:1024
    s_mov_b64 exec, 0xffff
    buffer_store_dwordx2 v[160:161], v26, s[48:51], s94 offen offset:0
    buffer_store_dwordx2 v[162:163], v26, s[48:51], s94 offen offset:1024
    buffer_store_dwordx2 v[164:165], v26, s[48:51], s94 offen offset:2048
    buffer_store_dwordx2 v[166:167], v26, s[48:51], s94 offen offset:3072
    s_mov_b64 exec, -1
    s_barrier
    v_readfirstlane_b32 s86, v120
    v_lshlrev_b32 v126, 7, v127
    s_sub_u32 s90, s74, 384
    s_add_u32 s89, s86, 0x10100
    s_and_b32 s89, s89, 0xffffff00
    s_or_b32 s89, s89, 16
    v_mov_b32 v255, s89
    s_mov_b64 exec, 15
    s_waitcnt vmcnt(0)
    buffer_store_dword v255, v126, s[48:51], s90 offen
    s_mov_b64 exec, -1
    v_readfirstlane_b32 s86, v120
    s_lshl_b32 s89, s56, 7
    s_lshl2_add_u32 s90, s57, s89
    s_add_u32 s90, s90, 69632
    s_add_u32 s89, s86, 0x10100
    s_and_b32 s61, s89, 0xffffff00
    s_and_b32 s62, s89, 0x3fff0000
    s_or_b32 s89, s61, 16
    v_mov_b32 v255, s89
    s_or_b32 s89, s61, s87
    v_mov_b32 v112, s89
    s_mov_b64 exec, 1
    buffer_store_dword v112, off, s[48:51], s90 sc1
    s_mov_b64 exec, -1
    s_cmp_eq_u32 s78, 0
    s_cbranch_scc1 L_nohalo_9
    s_lshl_b32 s89, s59, 10
    s_add_u32 s89, s89, s77
    s_add_u32 s89, s89, 16384
    s_mov_b32 s96, 0xff00ff00
    s_mov_b32 s97, 0xff00ff00
    s_mov_b64 exec, s[96:97]
    buffer_store_dwordx4 v[152:155], v243, s[48:51], s89 offen sc1
    buffer_store_dwordx4 v[156:159], v243, s[48:51], s89 offen offset:512 sc1
    s_lshl_b32 s89, s59, 7
    s_add_u32 s89, s89, s77
    s_add_u32 s89, s89, 30720
    s_mov_b64 exec, 0xffff
    buffer_store_dwordx2 v[166:167], v26, s[48:51], s89 offen sc1
    s_mov_b64 exec, -1
L_nohalo_9:
    s_mov_b32 s84, s78
    s_branch L_pub_10
L_idle_8:
    s_waitcnt vmcnt(0)
    v_readfirstlane_b32 s86, v120
    s_lshl_b32 s89, s56, 7
    s_lshl2_add_u32 s90, s57, s89
    s_add_u32 s90, s90, 69632
    s_add_u32 s89, s86, 0x10100
    s_and_b32 s61, s89, 0xffffff00
    s_and_b32 s62, s89, 0x3fff0000
    s_or_b32 s89, s61, 16
    v_mov_b32 v255, s89
    s_or_b32 s89, s61, s87
    v_mov_b32 v112, s89
    s_mov_b64 exec, 1
    buffer_store_dword v112, off, s[48:51], s90 sc1
    s_mov_b64 exec, -1
    s_barrier
L_pub_10:
    s_barrier
    s_cmp_ge_u32 s56, 14
    s_cbranch_scc1 L_nofw_11
    s_mul_i32 s90, s57, 56
    s_mul_i32 s89, s56, 86016
    s_add_u32 s90, s90, s89
    s_mov_b32 m0, 86016
    s_add_u32 s89, s90, 0
    buffer_load_dwordx4 v11, s[36:39], s89 offen lds
    s_mov_b32 m0, 87040
    s_add_u32 s89, s90, 43008
    buffer_load_dwordx4 v11, s[36:39], s89 offen lds
    s_mov_b32 m0, 88064
    s_add_u32 s89, s90, 896
    buffer_load_dwordx4 v11, s[36:39], s89 offen lds
    s_mov_b32 m0, 89088
    s_add_u32 s89, s90, 43904
    buffer_load_dwordx4 v11, s[36:39], s89 offen lds
    s_mov_b32 m0, 90112
    s_add_u32 s89, s90, 1792
    buffer_load_dwordx4 v11, s[36:39], s89 offen lds
    s_mov_b32 m0, 91136
    s_add_u32 s89, s90, 44800
    buffer_load_dwordx4 v11, s[36:39], s89 offen lds
L_nofw_11:
    s_mul_i32 s89, s57, 1568
    s_mov_b32 m0, 159744
    s_mul_i32 s90, s2, 1664
    s_min_u32 s90, s90, 399744
    v_min_u32 v126, 55, v127
    v_lshlrev_b32 v126, 7, v126
    s_lshr_b32 s93, s57, 1
    s_lshl_b32 s93, s93, 14
    s_and_b32 s94, s57, 1
    s_mul_i32 s94, s94, 7168
    s_add_u32 s93, s93, s94
    s_add_u32 s93, s93, s70
    s_sub_u32 s93, s93, 98304
    buffer_load_dwordx4 v1, s[52:55], s89 offen lds
    buffer_load_dwordx4 v1, s[52:55], s89 offen offset:1024 lds
    buffer_load_dword v245, v122, s[32:35], s90 offen
    buffer_load_dword v245, v122, s[40:43], s90 offen
    buffer_load_dword v245, v126, s[48:51], s93 offen
    v_lshlrev_b32 v112, 7, v116
    s_lshl_b32 s93, s56, 9
    s_add_u32 s93, s93, 20480
    buffer_load_dword v245, v112, s[48:51], s93 offen
    s_branch L_setup
L_walk:
    s_cmp_eq_u32 s84, 0
    s_cbranch_scc1 L_nohw_12
    s_waitcnt vmcnt(6)
    s_lshl2_add_u32 s89, s59, s79
    s_mov_b64 exec, 1
    buffer_store_dword v255, off, s[48:51], s89 offset:128 sc1
    s_mov_b64 exec, -1
    s_mov_b32 s84, 0
L_nohw_12:
    s_cmp_ge_u32 s56, 14
    s_cbranch_scc1 L_nofw_13
    v_bfe_u32 v112, v1, 4, 5
    v_bfe_u32 v116, v1, 6, 1
    v_lshlrev_b32 v112, 6, v112
    v_lshlrev_b32 v116, 5, v116
    v_xor_b32 v116, 56, v116
    v_add_u32 v112, v112, v116
    v_add_u32 v112, 86016, v112
    v_mov_b32 v116, 0
    v_mov_b32 v117, 0
    v_add_u32 v113, 86016, v2
    v_add_u32 v115, 86016, v3
    s_waitcnt vmcnt(6)
    ds_write_b64 v112, v[116:117] offset:0
    ds_read_b64_tr_b16 v[168:169], v113 offset:0
    ds_read_b64_tr_b16 v[170:171], v113 offset:1024
    ds_read_b64_tr_b16 v[172:173], v115 offset:0
    ds_read_b64_tr_b16 v[174:175], v115 offset:1024
    ds_write_b64 v112, v[116:117] offset:2048
    ds_read_b64_tr_b16 v[176:177], v113 offset:2048
    ds_read_b64_tr_b16 v[178:179], v113 offset:3072
    ds_read_b64_tr_b16 v[180:181], v115 offset:2048
    ds_read_b64_tr_b16 v[182:183], v115 offset:3072
    ds_write_b64 v112, v[116:117] offset:4096
    ds_read_b64_tr_b16 v[184:185], v113 offset:4096
    ds_read_b64_tr_b16 v[186:187], v113 offset:5120
    ds_read_b64_tr_b16 v[188:189], v115 offset:4096
    ds_read_b64_tr_b16 v[190:191], v115 offset:5120
    s_lshl_b32 s89, s56, 11
    s_add_u32 s89, s89, s4
    s_sub_u32 s89, s89, 21504
    s_add_u32 s90, s89, 0
    s_waitcnt lgkmcnt(12)
    buffer_store_dwordx4 v[168:171], v1, s[48:51], s90 offen offset:0 sc1
    s_waitcnt lgkmcnt(10)
    buffer_store_dwordx4 v[172:175], v1, s[48:51], s90 offen offset:1024 sc1
    s_add_u32 s90, s89, 28672
    s_waitcnt lgkmcnt(7)
    buffer_store_dwordx4 v[176:179], v1, s[48:51], s90 offen offset:0 sc1
    s_waitcnt lgkmcnt(5)
    buffer_store_dwordx4 v[180:183], v1, s[48:51], s90 offen offset:1024 sc1
    s_add_u32 s90, s89, 57344
    s_waitcnt lgkmcnt(2)
    buffer_store_dwordx4 v[184:187], v1, s[48:51], s90 offen offset:0 sc1
    s_waitcnt lgkmcnt(0)
    buffer_store_dwordx4 v[188:191], v1, s[48:51], s90 offen offset:1024 sc1
    s_lshl_b32 s89, s57, 7
    s_lshl_b32 s90, s56, 2
    s_add_u32 s89, s89, s90
    s_add_u32 s93, s89, 73728
    s_waitcnt vmcnt(0)
    s_mov_b64 exec, 1
    buffer_store_dword v255, off, s[48:51], s93 sc1
    s_mov_b64 exec, -1
L_nofw_13:
    s_branch L_qa1
.p2align 12
.fill 128, 4, 0xbf800000
L_qa1:
    v_mad_u32_u24 v112, v30, s66, v29
    buffer_load_dword v114, v14, s[48:51], 0 offen sc1
    s_waitcnt lgkmcnt(0)
    s_barrier
    v_lshrrev_b32 v204, 8, v1
    v_lshlrev_b32 v204, 4, v204
    v_add_u32 v204, 161792, v204
    ds_read_b128 v[64:67], v204 offset:0
    ds_read_b128 v[68:71], v204 offset:64
    ds_read_b128 v[72:75], v204 offset:128
    ds_read_b128 v[76:79], v204 offset:192
    ds_read_b128 v[80:83], v204 offset:256
    ds_read_b128 v[84:87], v204 offset:320
    s_lshl_b32 s88, s58, 6
    v_add_u32 v205, s88, v204
    ds_read_b128 v[32:35], v205 offset:128
    ds_read_b64 v[212:213], v0 offset:0
    ds_read_b64 v[214:215], v0 offset:32
    ds_read_b64 v[216:217], v0 offset:64
    ds_read_b64 v[218:219], v0 offset:96
    s_waitcnt lgkmcnt(3)
    v_lshlrev_b32 v48, 16, v212
    v_and_b32 v49, 0xffff0000, v212
    v_lshlrev_b32 v50, 16, v213
    v_and_b32 v51, 0xffff0000, v213
    s_waitcnt lgkmcnt(2)
    v_lshlrev_b32 v52, 16, v214
    v_and_b32 v53, 0xffff0000, v214
    v_lshlrev_b32 v54, 16, v215
    v_and_b32 v55, 0xffff0000, v215
    s_waitcnt lgkmcnt(1)
    v_lshlrev_b32 v56, 16, v216
    v_and_b32 v57, 0xffff0000, v216
    v_lshlrev_b32 v58, 16, v217
    v_and_b32 v59, 0xffff0000, v217
    s_waitcnt lgkmcnt(0)
    v_lshlrev_b32 v60, 16, v218
    v_and_b32 v61, 0xffff0000, v218
    v_lshlrev_b32 v62, 16, v219
    v_and_b32 v63, 0xffff0000, v219
    s_nop 1
L_once_22:
    ds_read_b128 a[168:171], v1 offset:0
    ds_read_b128 a[172:175], v1 offset:1024
    ds_read_b128 a[176:179], v1 offset:28672
    ds_read_b128 a[180:183], v1 offset:29696
    ds_read_b128 a[184:187], v240 offset:0
    ds_read_b128 a[188:191], v240 offset:1024
    s_branch L_qchk_21
L_qpoll_15:
    s_waitcnt vmcnt(0)
    buffer_load_dword v114, v14, s[48:51], 0 offen sc1
L_qchk_21:
    s_cmp_eq_u32 s84, 0
    s_waitcnt vmcnt(0)
    s_cbranch_scc0 L_pend_17
L_nopend_18:
    v_xor_b32 v113, v114, v112
    v_cmp_ne_u32 vcc, 0, v113
    s_cbranch_vccnz L_qslow_19
L_qpass_16:
    s_add_u32 s89, s68, 0
    s_add_u32 s90, s68, 14336
    buffer_load_dwordx4 a[0:3], v1, s[48:51], s89 offen offset:0 sc1
    buffer_load_dwordx4 a[4:7], v1, s[48:51], s90 offen offset:0 sc1
    buffer_load_dwordx4 a[8:11], v1, s[48:51], s89 offen offset:1024 sc1
    buffer_load_dwordx4 a[12:15], v1, s[48:51], s90 offen offset:1024 sc1
    buffer_load_dwordx4 a[16:19], v1, s[48:51], s89 offen offset:2048 sc1
    buffer_load_dwordx4 a[20:23], v1, s[48:51], s90 offen offset:2048 sc1
L_havex_14:
    s_waitcnt vmcnt(5) lgkmcnt(5)
    v_mfma_f32_16x16x32_bf16 v[112:115], a[168:171], a[0:3], 0
    s_waitcnt vmcnt(4)
    buffer_load_dwordx4 a[24:27], v1, s[48:51], s89 offen offset:3072 sc1
    v_mfma_f32_16x16x32_bf16 v[136:139], a[168:171], a[4:7], 0
    s_waitcnt lgkmcnt(4)
    ds_read_b128 a[168:171], v1 offset:2048
    v_mfma_f32_16x16x32_bf16 v[116:119], a[172:175], a[0:3], 0
    v_mad_u32_u24 v195, v28, s66, v13
    v_mfma_f32_16x16x32_bf16 v[140:143], a[172:175], a[4:7], 0
    s_waitcnt lgkmcnt(4)
    ds_read_b128 a[172:175], v1 offset:3072
    v_mfma_f32_16x16x32_bf16 v[120:123], a[176:179], a[0:3], 0
    buffer_load_dwordx4 a[28:31], v1, s[48:51], s90 offen offset:3072 sc1
    v_mfma_f32_16x16x32_bf16 v[144:147], a[176:179], a[4:7], 0
    s_waitcnt lgkmcnt(4)
    ds_read_b128 a[176:179], v1 offset:30720
    v_mfma_f32_16x16x32_bf16 v[124:127], a[180:183], a[0:3], 0
    v_mfma_f32_16x16x32_bf16 v[148:151], a[180:183], a[4:7], 0
    s_waitcnt lgkmcnt(4)
    ds_read_b128 a[180:183], v1 offset:31744
    v_mfma_f32_16x16x32_bf16 v[128:131], a[184:187], a[0:3], 0
    v_mfma_f32_16x16x32_bf16 v[152:155], a[184:187], a[4:7], 0
    s_waitcnt lgkmcnt(4)
    ds_read_b128 a[184:187], v240 offset:2048
    s_add_u32 s89, s68, 4096
    v_mfma_f32_16x16x32_bf16 v[132:135], a[188:191], a[0:3], 0
    s_add_u32 s90, s68, 18432
    buffer_load_dwordx4 a[32:35], v1, s[48:51], s89 offen offset:0 sc1
    v_mfma_f32_16x16x32_bf16 v[156:159], a[188:191], a[4:7], 0
    s_waitcnt vmcnt(6) lgkmcnt(4)
    ds_read_b128 a[188:191], v240 offset:3072
    v_mfma_f32_16x16x32_bf16 v[112:115], a[168:171], a[8:11], v[112:115]
    s_waitcnt vmcnt(5)
    v_mfma_f32_16x16x32_bf16 v[136:139], a[168:171], a[12:15], v[136:139]
    s_waitcnt lgkmcnt(4)
    ds_read_b128 a[168:171], v1 offset:4096
    buffer_load_dwordx4 a[36:39], v1, s[48:51], s90 offen offset:0 sc1
    v_mfma_f32_16x16x32_bf16 v[116:119], a[172:175], a[8:11], v[116:119]
    v_mfma_f32_16x16x32_bf16 v[140:143], a[172:175], a[12:15], v[140:143]
    s_waitcnt lgkmcnt(4)
    ds_read_b128 a[172:175], v1 offset:5120
    ds_read_b128 a[0:3], v6 offset:0
    v_mfma_f32_16x16x32_bf16 v[120:123], a[176:179], a[8:11], v[120:123]
    ds_read_b128 a[4:7], v6 offset:2048
    v_mfma_f32_16x16x32_bf16 v[144:147], a[176:179], a[12:15], v[144:147]
    s_waitcnt lgkmcnt(6)
    ds_read_b128 a[176:179], v1 offset:32768
    v_mfma_f32_16x16x32_bf16 v[124:127], a[180:183], a[8:11], v[124:127]
    buffer_load_dwordx4 a[40:43], v1, s[48:51], s89 offen offset:1024 sc1
    v_mfma_f32_16x16x32_bf16 v[148:151], a[180:183], a[12:15], v[148:151]
    s_waitcnt lgkmcnt(6)
    ds_read_b128 a[180:183], v1 offset:33792
    v_mfma_f32_16x16x32_bf16 v[128:131], a[184:187], a[8:11], v[128:131]
    v_mfma_f32_16x16x32_bf16 v[152:155], a[184:187], a[12:15], v[152:155]
    s_waitcnt lgkmcnt(6)
    ds_read_b128 a[184:187], v240 offset:4096
    v_mfma_f32_16x16x32_bf16 v[132:135], a[188:191], a[8:11], v[132:135]
    buffer_load_dwordx4 a[44:47], v1, s[48:51], s90 offen offset:1024 sc1
    v_mfma_f32_16x16x32_bf16 v[156:159], a[188:191], a[12:15], v[156:159]
    s_waitcnt vmcnt(7) lgkmcnt(6)
    ds_read_b128 a[188:191], v240 offset:5120
    v_mfma_f32_16x16x32_bf16 v[112:115], a[168:171], a[16:19], v[112:115]
    s_waitcnt vmcnt(6)
    v_mfma_f32_16x16x32_bf16 v[136:139], a[168:171], a[20:23], v[136:139]
    s_waitcnt lgkmcnt(6)
    ds_read_b128 a[168:171], v1 offset:6144
    v_mfma_f32_16x16x32_bf16 v[116:119], a[172:175], a[16:19], v[116:119]
    v_mfma_f32_16x16x32_bf16 v[140:143], a[172:175], a[20:23], v[140:143]
    s_waitcnt lgkmcnt(4)
    ds_read_b128 a[172:175], v1 offset:7168
    buffer_load_dwordx4 a[48:51], v1, s[48:51], s89 offen offset:2048 sc1
    v_mfma_f32_16x16x32_bf16 v[120:123], a[176:179], a[16:19], v[120:123]
    ds_read_b128 a[8:11], v6 offset:4096
    v_mfma_f32_16x16x32_bf16 v[144:147], a[176:179], a[20:23], v[144:147]
    s_waitcnt lgkmcnt(5)
    ds_read_b128 a[176:179], v1 offset:34816
    v_mfma_f32_16x16x32_bf16 v[124:127], a[180:183], a[16:19], v[124:127]
    v_mfma_f32_16x16x32_bf16 v[148:151], a[180:183], a[20:23], v[148:151]
    s_waitcnt lgkmcnt(5)
    ds_read_b128 a[180:183], v1 offset:35840
    buffer_load_dwordx4 a[52:55], v1, s[48:51], s90 offen offset:2048 sc1
    v_mfma_f32_16x16x32_bf16 v[128:131], a[184:187], a[16:19], v[128:131]
    v_mfma_f32_16x16x32_bf16 v[152:155], a[184:187], a[20:23], v[152:155]
    s_waitcnt lgkmcnt(5)
    ds_read_b128 a[184:187], v240 offset:6144
    v_mfma_f32_16x16x32_bf16 v[132:135], a[188:191], a[16:19], v[132:135]
    buffer_load_dwordx2 v[164:165], v21, s[48:51], s69 offen offset:0 sc1
    v_mfma_f32_16x16x32_bf16 v[156:159], a[188:191], a[20:23], v[156:159]
    s_waitcnt vmcnt(8) lgkmcnt(5)
    ds_read_b128 a[188:191], v240 offset:7168
    v_mfma_f32_16x16x32_bf16 v[112:115], a[168:171], a[24:27], v[112:115]
    s_waitcnt vmcnt(7)
    buffer_load_dwordx2 v[166:167], v21, s[48:51], s69 offen offset:512 sc1
    buffer_load_dwordx4 a[56:59], v1, s[48:51], s89 offen offset:3072 sc1
    v_mfma_f32_16x16x32_bf16 v[136:139], a[168:171], a[28:31], v[136:139]
    s_waitcnt lgkmcnt(5)
    ds_read_b128 a[168:171], v1 offset:8192
    v_mfma_f32_16x16x32_bf16 v[116:119], a[172:175], a[24:27], v[116:119]
    v_mfma_f32_16x16x32_bf16 v[140:143], a[172:175], a[28:31], v[140:143]
    s_waitcnt lgkmcnt(4)
    ds_read_b128 a[172:175], v1 offset:9216
    ds_read_b128 a[12:15], v6 offset:6144
    v_mfma_f32_16x16x32_bf16 v[120:123], a[176:179], a[24:27], v[120:123]
    buffer_load_dwordx4 a[60:63], v1, s[48:51], s90 offen offset:3072 sc1
    v_mfma_f32_16x16x32_bf16 v[144:147], a[176:179], a[28:31], v[144:147]
    s_waitcnt lgkmcnt(5)
    ds_read_b128 a[176:179], v1 offset:36864
    v_mfma_f32_16x16x32_bf16 v[124:127], a[180:183], a[24:27], v[124:127]
    v_mfma_f32_16x16x32_bf16 v[148:151], a[180:183], a[28:31], v[148:151]
    s_waitcnt lgkmcnt(5)
    ds_read_b128 a[180:183], v1 offset:37888
    buffer_load_dwordx2 v[168:169], v21, s[48:51], s69 offen offset:1024 sc1
    v_mfma_f32_16x16x32_bf16 v[128:131], a[184:187], a[24:27], v[128:131]
    v_mfma_f32_16x16x32_bf16 v[152:155], a[184:187], a[28:31], v[152:155]
    s_waitcnt lgkmcnt(5)
    ds_read_b128 a[184:187], v240 offset:8192
    buffer_load_dwordx2 v[170:171], v21, s[48:51], s69 offen offset:1536 sc1
    v_mfma_f32_16x16x32_bf16 v[132:135], a[188:191], a[24:27], v[132:135]
    s_add_u32 s89, s68, 8192
    s_add_u32 s90, s68, 22528
    buffer_load_dwordx4 a[64:67], v1, s[48:51], s89 offen offset:0 sc1
    v_mfma_f32_16x16x32_bf16 v[156:159], a[188:191], a[28:31], v[156:159]
    s_waitcnt vmcnt(12) lgkmcnt(5)
    ds_read_b128 a[188:191], v240 offset:9216
    v_mfma_f32_16x16x32_bf16 v[112:115], a[168:171], a[32:35], v[112:115]
    s_waitcnt vmcnt(11)
    v_mfma_f32_16x16x32_bf16 v[136:139], a[168:171], a[36:39], v[136:139]
    s_waitcnt lgkmcnt(5)
    ds_read_b128 a[168:171], v1 offset:10240
    buffer_load_dwordx4 a[68:71], v1, s[48:51], s90 offen offset:0 sc1
    v_mfma_f32_16x16x32_bf16 v[116:119], a[172:175], a[32:35], v[116:119]
    v_mfma_f32_16x16x32_bf16 v[140:143], a[172:175], a[36:39], v[140:143]
    s_waitcnt lgkmcnt(4)
    ds_read_b128 a[172:175], v1 offset:11264
    ds_read_b128 a[16:19], v6 offset:8192
    v_mfma_f32_16x16x32_bf16 v[120:123], a[176:179], a[32:35], v[120:123]
    ds_read_b128 a[20:23], v6 offset:10240
    v_mfma_f32_16x16x32_bf16 v[144:147], a[176:179], a[36:39], v[144:147]
    s_waitcnt lgkmcnt(6)
    ds_read_b128 a[176:179], v1 offset:38912
    v_mfma_f32_16x16x32_bf16 v[124:127], a[180:183], a[32:35], v[124:127]
    buffer_load_dwordx4 a[72:75], v1, s[48:51], s89 offen offset:1024 sc1
    v_mfma_f32_16x16x32_bf16 v[148:151], a[180:183], a[36:39], v[148:151]
    s_waitcnt lgkmcnt(6)
    ds_read_b128 a[180:183], v1 offset:39936
    v_mfma_f32_16x16x32_bf16 v[128:131], a[184:187], a[32:35], v[128:131]
    buffer_load_dword v194, v252, s[48:51], 0 offen sc1
    v_mfma_f32_16x16x32_bf16 v[152:155], a[184:187], a[36:39], v[152:155]
    s_waitcnt lgkmcnt(6)
    ds_read_b128 a[184:187], v240 offset:10240
    v_mfma_f32_16x16x32_bf16 v[132:135], a[188:191], a[32:35], v[132:135]
    buffer_load_dwordx4 a[76:79], v1, s[48:51], s90 offen offset:1024 sc1
    v_mfma_f32_16x16x32_bf16 v[156:159], a[188:191], a[36:39], v[156:159]
    s_waitcnt vmcnt(14) lgkmcnt(6)
    ds_read_b128 a[188:191], v240 offset:11264
    v_mfma_f32_16x16x32_bf16 v[112:115], a[168:171], a[40:43], v[112:115]
    s_waitcnt vmcnt(13)
    v_mfma_f32_16x16x32_bf16 v[136:139], a[168:171], a[44:47], v[136:139]
    s_waitcnt lgkmcnt(6)
    ds_read_b128 a[168:171], v1 offset:12288
    v_mfma_f32_16x16x32_bf16 v[116:119], a[172:175], a[40:43], v[116:119]
    v_mfma_f32_16x16x32_bf16 v[140:143], a[172:175], a[44:47], v[140:143]
    s_waitcnt lgkmcnt(4)
    ds_read_b128 a[172:175], v1 offset:13312
    buffer_load_dwordx4 a[80:83], v1, s[48:51], s89 offen offset:2048 sc1
    v_mfma_f32_16x16x32_bf16 v[120:123], a[176:179], a[40:43], v[120:123]
    ds_read_b128 a[24:27], v6 offset:12288
    v_mfma_f32_16x16x32_bf16 v[144:147], a[176:179], a[44:47], v[144:147]
    s_waitcnt lgkmcnt(5)
    ds_read_b128 a[176:179], v1 offset:40960
    v_mfma_f32_16x16x32_bf16 v[124:127], a[180:183], a[40:43], v[124:127]
    v_mfma_f32_16x16x32_bf16 v[148:151], a[180:183], a[44:47], v[148:151]
    s_waitcnt lgkmcnt(5)
    ds_read_b128 a[180:183], v1 offset:41984
    buffer_load_dwordx4 a[84:87], v1, s[48:51], s90 offen offset:2048 sc1
    v_mfma_f32_16x16x32_bf16 v[128:131], a[184:187], a[40:43], v[128:131]
    v_mfma_f32_16x16x32_bf16 v[152:155], a[184:187], a[44:47], v[152:155]
    s_waitcnt lgkmcnt(5)
    ds_read_b128 a[184:187], v240 offset:12288
    v_mfma_f32_16x16x32_bf16 v[132:135], a[188:191], a[40:43], v[132:135]
    v_mfma_f32_16x16x32_bf16 v[156:159], a[188:191], a[44:47], v[156:159]
    s_waitcnt vmcnt(14) lgkmcnt(5)
    ds_read_b128 a[188:191], v240 offset:13312
    v_mfma_f32_16x16x32_bf16 v[112:115], a[168:171], a[48:51], v[112:115]
    s_waitcnt vmcnt(13)
    buffer_load_dwordx4 a[88:91], v1, s[48:51], s89 offen offset:3072 sc1
    ds_read_b128 a[116:119], v244 offset:28672
    v_mfma_f32_16x16x32_bf16 v[136:139], a[168:171], a[52:55], v[136:139]
    s_waitcnt lgkmcnt(6)
    ds_read_b128 a[168:171], v1 offset:14336
    v_mfma_f32_16x16x32_bf16 v[116:119], a[172:175], a[48:51], v[116:119]
    v_mfma_f32_16x16x32_bf16 v[140:143], a[172:175], a[52:55], v[140:143]
    s_waitcnt lgkmcnt(5)
    ds_read_b128 a[172:175], v1 offset:15360
    ds_read_b128 a[28:31], v6 offset:14336
    v_mfma_f32_16x16x32_bf16 v[120:123], a[176:179], a[48:51], v[120:123]
    buffer_load_dwordx4 a[92:95], v1, s[48:51], s90 offen offset:3072 sc1
    ds_read_b128 a[120:123], v244 offset:29696
    v_mfma_f32_16x16x32_bf16 v[144:147], a[176:179], a[52:55], v[144:147]
    s_waitcnt lgkmcnt(7)
    ds_read_b128 a[176:179], v1 offset:43008
    v_mfma_f32_16x16x32_bf16 v[124:127], a[180:183], a[48:51], v[124:127]
    s_waitcnt vmcnt(13)
    v_and_b32 v166, v166, v20
    s_waitcnt vmcnt(9)
    v_and_b32 v170, v170, v20
    v_mfma_f32_16x16x32_bf16 v[148:151], a[180:183], a[52:55], v[148:151]
    s_waitcnt lgkmcnt(7)
    ds_read_b128 a[180:183], v1 offset:44032
    v_and_b32 v167, v167, v20
    v_mfma_f32_16x16x32_bf16 v[128:131], a[184:187], a[48:51], v[128:131]
    ds_read_b128 a[124:127], v244 offset:30720
    v_and_b32 v171, v171, v20
    v_mfma_f32_16x16x32_bf16 v[152:155], a[184:187], a[52:55], v[152:155]
    s_waitcnt lgkmcnt(8)
    ds_read_b128 a[184:187], v240 offset:14336
    s_add_u32 s89, s68, 12288
    v_mfma_f32_16x16x32_bf16 v[132:135], a[188:191], a[48:51], v[132:135]
    s_add_u32 s90, s68, 26624
    buffer_load_dwordx4 a[96:99], v1, s[48:51], s89 offen offset:0 sc1
    v_add_f32 v164, v164, v166
    v_mfma_f32_16x16x32_bf16 v[156:159], a[188:191], a[52:55], v[156:159]
    s_waitcnt lgkmcnt(7)
    ds_read_b128 a[188:191], v240 offset:15360
    v_add_f32 v168, v168, v170
    v_mfma_f32_16x16x32_bf16 v[112:115], a[168:171], a[56:59], v[112:115]
    ds_read_b128 a[128:131], v244 offset:31744
    v_add_f32 v165, v165, v167
    v_mfma_f32_16x16x32_bf16 v[136:139], a[168:171], a[60:63], v[136:139]
    s_waitcnt lgkmcnt(8)
    ds_read_b128 a[168:171], v1 offset:16384
    buffer_load_dwordx4 a[100:103], v1, s[48:51], s90 offen offset:0 sc1
    v_mfma_f32_16x16x32_bf16 v[116:119], a[172:175], a[56:59], v[116:119]
    v_add_f32 v169, v169, v171
    v_mfma_f32_16x16x32_bf16 v[140:143], a[172:175], a[60:63], v[140:143]
    s_waitcnt lgkmcnt(6)
    ds_read_b128 a[172:175], v1 offset:17408
    ds_read_b128 a[32:35], v6 offset:16384
    v_mfma_f32_16x16x32_bf16 v[120:123], a[176:179], a[56:59], v[120:123]
    ds_read_b128 a[132:135], v244 offset:32768
    v_mfma_f32_16x16x32_bf16 v[144:147], a[176:179], a[60:63], v[144:147]
    s_waitcnt lgkmcnt(8)
    ds_read_b128 a[176:179], v1 offset:45056
    v_mfma_f32_16x16x32_bf16 v[124:127], a[180:183], a[56:59], v[124:127]
    buffer_load_dwordx4 a[104:107], v1, s[48:51], s89 offen offset:1024 sc1
    v_mfma_f32_16x16x32_bf16 v[148:151], a[180:183], a[60:63], v[148:151]
    s_waitcnt lgkmcnt(7)
    ds_read_b128 a[180:183], v1 offset:46080
    v_mfma_f32_16x16x32_bf16 v[128:131], a[184:187], a[56:59], v[128:131]
    ds_read_b128 a[136:139], v244 offset:33792
    v_mfma_f32_16x16x32_bf16 v[152:155], a[184:187], a[60:63], v[152:155]
    s_waitcnt lgkmcnt(8)
    ds_read_b128 a[184:187], v240 offset:16384
    v_mfma_f32_16x16x32_bf16 v[132:135], a[188:191], a[56:59], v[132:135]
    buffer_load_dwordx4 a[108:111], v1, s[48:51], s90 offen offset:1024 sc1
    v_mfma_f32_16x16x32_bf16 v[156:159], a[188:191], a[60:63], v[156:159]
    s_waitcnt vmcnt(12) lgkmcnt(7)
    ds_read_b128 a[188:191], v240 offset:17408
    v_mfma_f32_16x16x32_bf16 v[112:115], a[168:171], a[64:67], v[112:115]
    s_waitcnt vmcnt(11)
    s_waitcnt vmcnt(9)
    v_cmp_ne_u32 vcc, v195, v194
    s_cbranch_vccnz L_hslow_23
L_hback_24:
    s_lshl_b32 s88, s58, 11
    v_mfma_f32_16x16x32_bf16 v[136:139], a[168:171], a[68:71], v[136:139]
    s_waitcnt lgkmcnt(7)
    ds_read_b128 a[168:171], v1 offset:18432
    s_add_u32 m0, s88, 151552
    v_mfma_f32_16x16x32_bf16 v[116:119], a[172:175], a[64:67], v[116:119]
    s_add_u32 s88, s88, s77
    buffer_load_dwordx4 v24, s[48:51], s88 offen offset:0 sc1 lds
    buffer_load_dwordx4 v24, s[48:51], s88 offen offset:1024 sc1 lds
    v_mfma_f32_16x16x32_bf16 v[140:143], a[172:175], a[68:71], v[140:143]
    s_waitcnt lgkmcnt(5)
    ds_read_b128 a[172:175], v1 offset:19456
    s_add_u32 s88, s77, 14336
    v_mfma_f32_16x16x32_bf16 v[120:123], a[176:179], a[64:67], v[120:123]
    buffer_load_dwordx2 v[172:173], v25, s[48:51], s88 offen offset:0 sc1
    buffer_load_dwordx2 v[174:175], v25, s[48:51], s88 offen offset:512 sc1
    v_mfma_f32_16x16x32_bf16 v[144:147], a[176:179], a[68:71], v[144:147]
    s_waitcnt lgkmcnt(5)
    ds_read_b128 a[176:179], v1 offset:47104
    v_add_u32 v194, 151552, v243
    v_mfma_f32_16x16x32_bf16 v[124:127], a[180:183], a[64:67], v[124:127]
    ds_read_b128 a[36:39], v6 offset:18432
    ds_read_b128 a[40:43], v6 offset:20480
    v_mfma_f32_16x16x32_bf16 v[148:151], a[180:183], a[68:71], v[148:151]
    s_waitcnt lgkmcnt(6)
    ds_read_b128 a[180:183], v1 offset:48128
    ds_read_b128 a[140:143], v244 offset:34816
    v_mfma_f32_16x16x32_bf16 v[128:131], a[184:187], a[64:67], v[128:131]
    ds_read_b128 a[144:147], v244 offset:57344
    ds_read_b128 a[148:151], v244 offset:58368
    v_mfma_f32_16x16x32_bf16 v[152:155], a[184:187], a[68:71], v[152:155]
    s_waitcnt lgkmcnt(9)
    ds_read_b128 a[184:187], v240 offset:18432
    v_mfma_f32_16x16x32_bf16 v[132:135], a[188:191], a[64:67], v[132:135]
    v_permlane32_swap_b32 v164, v165
    v_mfma_f32_16x16x32_bf16 v[156:159], a[188:191], a[68:71], v[156:159]
    s_waitcnt lgkmcnt(9)
    ds_read_b128 a[188:191], v240 offset:19456
    v_mfma_f32_16x16x32_bf16 v[112:115], a[168:171], a[72:75], v[112:115]
    s_waitcnt vmcnt(12)
    ds_read_b128 a[152:155], v244 offset:59392
    v_mfma_f32_16x16x32_bf16 v[136:139], a[168:171], a[76:79], v[136:139]
    s_waitcnt lgkmcnt(10)
    ds_read_b128 a[168:171], v1 offset:20480
    v_mfma_f32_16x16x32_bf16 v[116:119], a[172:175], a[72:75], v[116:119]
    v_permlane32_swap_b32 v168, v169
    v_mfma_f32_16x16x32_bf16 v[140:143], a[172:175], a[76:79], v[140:143]
    s_waitcnt lgkmcnt(10)
    ds_read_b128 a[172:175], v1 offset:21504
    ds_read_b128 a[44:47], v6 offset:22528
    v_mfma_f32_16x16x32_bf16 v[120:123], a[176:179], a[72:75], v[120:123]
    ds_read_b128 a[156:159], v244 offset:60416
    v_add_f32 v164, v164, v165
    v_mfma_f32_16x16x32_bf16 v[144:147], a[176:179], a[76:79], v[144:147]
    s_waitcnt lgkmcnt(10)
    ds_read_b128 a[176:179], v1 offset:49152
    v_add_f32 v168, v168, v169
    v_mfma_f32_16x16x32_bf16 v[124:127], a[180:183], a[72:75], v[124:127]
    v_mov_b32 v165, v164
    v_mov_b32 v169, v168
    v_mfma_f32_16x16x32_bf16 v[148:151], a[180:183], a[76:79], v[148:151]
    s_waitcnt lgkmcnt(7)
    ds_read_b128 a[180:183], v1 offset:50176
    v_mfma_f32_16x16x32_bf16 v[128:131], a[184:187], a[72:75], v[128:131]
    ds_read_b128 a[160:163], v244 offset:61440
    v_mfma_f32_16x16x32_bf16 v[152:155], a[184:187], a[76:79], v[152:155]
    s_waitcnt lgkmcnt(8)
    ds_read_b128 a[184:187], v240 offset:20480
    v_mfma_f32_16x16x32_bf16 v[132:135], a[188:191], a[72:75], v[132:135]
    v_permlane16_swap_b32 v164, v165
    v_mfma_f32_16x16x32_bf16 v[156:159], a[188:191], a[76:79], v[156:159]
    s_waitcnt vmcnt(11) lgkmcnt(7)
    ds_read_b128 a[188:191], v240 offset:21504
    v_mfma_f32_16x16x32_bf16 v[112:115], a[168:171], a[80:83], v[112:115]
    s_waitcnt vmcnt(10)
    ds_read_b128 a[164:167], v244 offset:62464
    v_mfma_f32_16x16x32_bf16 v[136:139], a[168:171], a[84:87], v[136:139]
    s_waitcnt lgkmcnt(8)
    ds_read_b128 a[168:171], v1 offset:22528
    v_mfma_f32_16x16x32_bf16 v[116:119], a[172:175], a[80:83], v[116:119]
    s_add_u32 m0, s6, 0
    s_add_u32 s93, s7, 0
    buffer_load_dwordx4 v246, s[32:35], s93 offen lds
    v_mfma_f32_16x16x32_bf16 v[140:143], a[172:175], a[84:87], v[140:143]
    s_waitcnt lgkmcnt(6)
    ds_read_b128 a[172:175], v1 offset:23552
    ds_read_b128 a[48:51], v6 offset:24576
    v_mfma_f32_16x16x32_bf16 v[120:123], a[176:179], a[80:83], v[120:123]
    ds_read_b128 a[200:203], v244 offset:63488
    v_mfma_f32_16x16x32_bf16 v[144:147], a[176:179], a[84:87], v[144:147]
    s_waitcnt lgkmcnt(8)
    ds_read_b128 a[176:179], v1 offset:51200
    v_mfma_f32_16x16x32_bf16 v[124:127], a[180:183], a[80:83], v[124:127]
    v_permlane16_swap_b32 v168, v169
    v_mfma_f32_16x16x32_bf16 v[148:151], a[180:183], a[84:87], v[148:151]
    s_waitcnt lgkmcnt(7)
    ds_read_b128 a[180:183], v1 offset:52224
    s_addk_i32 m0, 4096
    v_mfma_f32_16x16x32_bf16 v[128:131], a[184:187], a[80:83], v[128:131]
    s_addk_i32 s93, 28672
    ds_read_b128 a[204:207], v244 offset:0
    buffer_load_dwordx4 v246, s[32:35], s93 offen lds
    v_mfma_f32_16x16x32_bf16 v[152:155], a[184:187], a[84:87], v[152:155]
    s_waitcnt lgkmcnt(8)
    ds_read_b128 a[184:187], v240 offset:22528
    v_add_f32 v164, v164, v165
    v_mfma_f32_16x16x32_bf16 v[132:135], a[188:191], a[80:83], v[132:135]
    v_add_f32 v168, v168, v169
    v_mov_b32 v165, v164
    v_mfma_f32_16x16x32_bf16 v[156:159], a[188:191], a[84:87], v[156:159]
    s_waitcnt vmcnt(11) lgkmcnt(7)
    ds_read_b128 a[188:191], v240 offset:23552
    v_mov_b32 v169, v168
    v_mfma_f32_16x16x32_bf16 v[112:115], a[168:171], a[88:91], v[112:115]
    s_waitcnt vmcnt(10)
    ds_read_b128 a[208:211], v244 offset:1024
    s_addk_i32 m0, 4096
    v_mfma_f32_16x16x32_bf16 v[136:139], a[168:171], a[92:95], v[136:139]
    s_waitcnt lgkmcnt(8)
    ds_read_b128 a[168:171], v1 offset:24576
    s_addk_i32 s93, 28672
    v_mfma_f32_16x16x32_bf16 v[116:119], a[172:175], a[88:91], v[116:119]
    buffer_load_dwordx4 v246, s[32:35], s93 offen lds
    v_mfma_f32_16x16x32_bf16 v[140:143], a[172:175], a[92:95], v[140:143]
    s_waitcnt lgkmcnt(6)
    ds_read_b128 a[172:175], v1 offset:25600
    ds_read_b128 a[52:55], v6 offset:26624
    v_mfma_f32_16x16x32_bf16 v[120:123], a[176:179], a[88:91], v[120:123]
    ds_read_b128 a[212:215], v244 offset:2048
    v_mfma_f32_16x16x32_bf16 v[144:147], a[176:179], a[92:95], v[144:147]
    s_waitcnt lgkmcnt(8)
    ds_read_b128 a[176:179], v1 offset:53248
    ds_read_b128 a[192:195], v1 offset:55296
    v_mfma_f32_16x16x32_bf16 v[124:127], a[180:183], a[88:91], v[124:127]
    s_addk_i32 m0, 4096
    s_addk_i32 s93, 28672
    buffer_load_dwordx4 v246, s[32:35], s93 offen lds
    v_mfma_f32_16x16x32_bf16 v[148:151], a[180:183], a[92:95], v[148:151]
    s_waitcnt lgkmcnt(8)
    ds_read_b128 a[180:183], v1 offset:54272
    ds_read_b128 a[196:199], v1 offset:56320
    v_mfma_f32_16x16x32_bf16 v[128:131], a[184:187], a[88:91], v[128:131]
    ds_read_b128 a[216:219], v244 offset:3072
    v_mfma_f32_16x16x32_bf16 v[152:155], a[184:187], a[92:95], v[152:155]
    s_waitcnt lgkmcnt(10)
    ds_read_b128 a[184:187], v240 offset:24576
    v_mfma_f32_16x16x32_bf16 v[132:135], a[188:191], a[88:91], v[132:135]
    s_addk_i32 m0, 4096
    s_addk_i32 s93, 28672
    buffer_load_dwordx4 v246, s[32:35], s93 offen lds
    v_mfma_f32_16x16x32_bf16 v[156:159], a[188:191], a[92:95], v[156:159]
    s_waitcnt vmcnt(11) lgkmcnt(5)
    ds_read_b128 a[188:191], v240 offset:25600
    v_mfma_f32_16x16x32_bf16 v[144:147], a[176:179], a[100:103], v[144:147]
    ds_read_b128 a[220:223], v244 offset:4096
    s_waitcnt vmcnt(5)
    v_and_b32 v174, v174, v20
    v_mfma_f32_16x16x32_bf16 v[120:123], a[176:179], a[96:99], v[120:123]
    s_waitcnt lgkmcnt(5)
    ds_read_b128 a[176:179], v240 offset:26624
    v_and_b32 v175, v175, v20
    v_mfma_f32_16x16x32_bf16 v[148:151], a[180:183], a[100:103], v[148:151]
    v_permlane32_swap_b32 v164, v165
    v_mfma_f32_16x16x32_bf16 v[124:127], a[180:183], a[96:99], v[124:127]
    s_addk_i32 m0, 4096
    ds_read_b128 a[180:183], v240 offset:27648
    s_addk_i32 s93, 28672
    v_mfma_f32_16x16x32_bf16 v[144:147], a[192:195], a[108:111], v[144:147]
    ds_read_b128 a[224:227], v244 offset:5120
    buffer_load_dwordx4 v246, s[32:35], s93 offen lds
    v_mfma_f32_16x16x32_bf16 v[120:123], a[192:195], a[104:107], v[120:123]
    s_waitcnt lgkmcnt(7)
    ds_read_b128 a[192:195], v1 offset:26624
    v_add_f32 v172, v172, v174
    v_mfma_f32_16x16x32_bf16 v[148:151], a[196:199], a[108:111], v[148:151]
    v_permlane32_swap_b32 v168, v169
    v_mfma_f32_16x16x32_bf16 v[124:127], a[196:199], a[104:107], v[124:127]
    s_waitcnt lgkmcnt(6)
    ds_read_b128 a[196:199], v1 offset:27648
    v_mul_f32 v176, 0xbb124925, v164
    v_mfma_f32_16x16x32_bf16 v[152:155], a[184:187], a[100:103], v[152:155]
    s_addk_i32 m0, 4096
    ds_read_b128 a[228:231], v244 offset:6144
    s_addk_i32 s93, 28672
    v_mfma_f32_16x16x32_bf16 v[128:131], a[184:187], a[96:99], v[128:131]
    s_waitcnt lgkmcnt(7)
    buffer_load_dwordx4 v246, s[32:35], s93 offen lds
    v_mul_f32 v180, 0xbb124925, v168
    v_mfma_f32_16x16x32_bf16 v[156:159], a[188:191], a[100:103], v[156:159]
    v_mul_f32 v188, 0x3b124925, v165
    v_mul_f32 v190, 0x3b124925, v169
    v_mfma_f32_16x16x32_bf16 v[132:135], a[188:191], a[96:99], v[132:135]
    s_waitcnt lgkmcnt(5)
    v_fma_f32 v188, -v176, v176, v188
    v_fma_f32 v190, -v180, v180, v190
    v_mfma_f32_16x16x32_bf16 v[152:155], a[176:179], a[108:111], v[152:155]
    v_max_f32 v188, 0, v188
    v_max_f32 v190, 0, v190
    v_mfma_f32_16x16x32_bf16 v[128:131], a[176:179], a[104:107], v[128:131]
    s_waitcnt lgkmcnt(4)
    s_waitcnt lgkmcnt(0)
    v_mfma_f32_16x16x32_bf16 v[156:159], a[180:183], a[108:111], v[156:159]
    s_barrier
    ds_read_b128 a[56:59], v194 offset:0
    ds_read_b128 a[60:63], v194 offset:512
    v_mfma_f32_16x16x32_bf16 v[132:135], a[180:183], a[104:107], v[132:135]
    s_addk_i32 m0, 4096
    ds_read_b128 a[64:67], v194 offset:1024
    ds_read_b128 a[68:71], v194 offset:1536
    v_mfma_f32_16x16x32_bf16 v[136:139], a[168:171], a[100:103], v[136:139]
    s_addk_i32 s93, 28672
    ds_read_b128 a[72:75], v194 offset:2048
    ds_read_b128 a[76:79], v194 offset:2560
    v_mfma_f32_16x16x32_bf16 v[112:115], a[168:171], a[96:99], v[112:115]
    ds_read_b128 a[80:83], v194 offset:3072
    ds_read_b128 a[84:87], v194 offset:3584
    v_mfma_f32_16x16x32_bf16 v[140:143], a[172:175], a[100:103], v[140:143]
    ds_read_b128 a[88:91], v194 offset:4096
    ds_read_b128 a[92:95], v194 offset:4608
    v_mfma_f32_16x16x32_bf16 v[116:119], a[172:175], a[96:99], v[116:119]
    buffer_load_dwordx4 v246, s[32:35], s93 offen lds
    s_lshr_b32 s91, s56, 1
    v_mfma_f32_16x16x32_bf16 v[136:139], a[192:195], a[108:111], v[136:139]
    s_lshl_b32 s91, s91, 10
    s_add_u32 s91, s91, s81
    s_add_u32 s91, s91, 8192
    v_mfma_f32_16x16x32_bf16 v[112:115], a[192:195], a[104:107], v[112:115]
    buffer_load_dword v245, v1, s[48:51], s91 offen
    v_add_f32 v188, 0x3727c5ac, v188
    v_mfma_f32_16x16x32_bf16 v[140:143], a[196:199], a[108:111], v[140:143]
    s_add_u32 m0, s5, 28672
    s_add_u32 s94, s4, 28672
    buffer_load_dwordx4 v1, s[48:51], s94 offen lds
    v_mfma_f32_16x16x32_bf16 v[116:119], a[196:199], a[104:107], v[116:119]
    s_waitcnt lgkmcnt(9)
    ds_read_b128 a[96:99], v194 offset:5120
    ds_read_b128 a[100:103], v194 offset:5632
    v_mfma_f32_16x16x32_bf16 v[160:163], a[0:3], a[56:59], 0
    s_waitcnt lgkmcnt(10)
    ds_read_b128 a[192:195], v194 offset:6144
    ds_read_b128 a[196:199], v194 offset:6656
    v_mfma_f32_16x16x32_bf16 v[160:163], a[4:7], a[60:63], v[160:163]
    s_waitcnt lgkmcnt(11)
    v_add_f32 v190, 0x3727c5ac, v190
    v_add_f32 v173, v173, v175
    v_mfma_f32_16x16x32_bf16 v[160:163], a[8:11], a[64:67], v[160:163]
    s_waitcnt lgkmcnt(10)
    v_rsq_f32 v177, v188
    v_mfma_f32_16x16x32_bf16 v[160:163], a[12:15], a[68:71], v[160:163]
    s_waitcnt lgkmcnt(9)
    s_add_u32 m0, s5, 29696
    s_add_u32 s94, s4, 29696
    buffer_load_dwordx4 v1, s[48:51], s94 offen lds
    v_mfma_f32_16x16x32_bf16 v[160:163], a[16:19], a[72:75], v[160:163]
    s_waitcnt lgkmcnt(8)
    v_rsq_f32 v181, v190
    v_mfma_f32_16x16x32_bf16 v[160:163], a[20:23], a[76:79], v[160:163]
    s_waitcnt lgkmcnt(7)
    v_and_b32 v178, v177, v20
    v_and_b32 v182, v181, v20
    v_mfma_f32_16x16x32_bf16 v[160:163], a[24:27], a[80:83], v[160:163]
    s_waitcnt lgkmcnt(6)
    v_mul_f32 v179, 0x3e8b97f6, v177
    v_mul_f32 v183, 0x3e8b97f6, v181
    v_mfma_f32_16x16x32_bf16 v[160:163], a[28:31], a[84:87], v[160:163]
    s_waitcnt lgkmcnt(5)
    v_fma_f32 v144, v72, v180, v144
    v_fma_f32 v145, v73, v180, v145
    v_mfma_f32_16x16x32_bf16 v[160:163], a[32:35], a[88:91], v[160:163]
    s_waitcnt lgkmcnt(4)
    v_fma_f32 v146, v74, v180, v146
    v_fma_f32 v147, v75, v180, v147
    v_mfma_f32_16x16x32_bf16 v[160:163], a[36:39], a[92:95], v[160:163]
    s_waitcnt lgkmcnt(3)
    v_mul_f32 v144, v144, v181
    v_mul_f32 v145, v145, v181
    v_mfma_f32_16x16x32_bf16 v[160:163], a[40:43], a[96:99], v[160:163]
    s_waitcnt lgkmcnt(2)
    v_mul_f32 v146, v146, v181
    v_mul_f32 v147, v147, v181
    v_mfma_f32_16x16x32_bf16 v[160:163], a[44:47], a[100:103], v[160:163]
    s_waitcnt lgkmcnt(1)
    v_cvt_pk_bf16_f32 v200, v144, v145
    v_cvt_pk_bf16_f32 v201, v146, v147
    v_mfma_f32_16x16x32_bf16 v[160:163], a[48:51], a[192:195], v[160:163]
    s_waitcnt lgkmcnt(0)
    v_fma_f32 v148, v76, v180, v148
    v_fma_f32 v149, v77, v180, v149
    v_mfma_f32_16x16x32_bf16 v[160:163], a[52:55], a[196:199], v[160:163]
    v_fma_f32 v150, v78, v180, v150
    v_fma_f32 v151, v79, v180, v151
    v_mul_f32 v148, v148, v182
    v_mul_f32 v149, v149, v182
    v_mul_f32 v150, v150, v182
    v_mul_f32 v151, v151, v182
    v_cvt_pk_bf16_f32 v202, v148, v149
    v_cvt_pk_bf16_f32 v203, v150, v151
    ds_write_b128 v253, v[200:203] offset:1024
    v_fma_f32 v152, v80, v180, v152
    v_fma_f32 v153, v81, v180, v153
    v_fma_f32 v154, v82, v180, v154
    v_fma_f32 v155, v83, v180, v155
    v_mul_f32 v152, v152, v181
    v_mul_f32 v153, v153, v181
    v_mul_f32 v154, v154, v181
    v_mul_f32 v155, v155, v181
    v_cvt_pk_bf16_f32 v216, v152, v153
    v_cvt_pk_bf16_f32 v217, v154, v155
    v_fma_f32 v156, v84, v180, v156
    v_fma_f32 v157, v85, v180, v157
    v_fma_f32 v158, v86, v180, v158
    v_fma_f32 v159, v87, v180, v159
    v_mul_f32 v156, v156, v181
    v_mul_f32 v157, v157, v181
    v_mul_f32 v158, v158, v181
    v_mul_f32 v159, v159, v181
    v_cvt_pk_bf16_f32 v218, v156, v157
    v_cvt_pk_bf16_f32 v219, v158, v159
    ds_write_b128 v17, v[216:219] offset:2048
    v_permlane32_swap_b32 v172, v173
    v_add_f32 v172, v172, v173
    v_mov_b32 v173, v172
    s_nop 1
    v_permlane16_swap_b32 v172, v173
    v_add_f32 v172, v172, v173
    v_mov_b32 v173, v172
    s_nop 1
    v_permlane32_swap_b32 v172, v173
    v_mul_f32 v184, 0xbb124925, v172
    v_mul_f32 v192, 0x3b124925, v173
    v_fma_f32 v192, -v184, v184, v192
    v_max_f32 v192, 0, v192
    v_add_f32 v192, 0x3727c5ac, v192
    v_rsq_f32 v185, v192
    s_nop 0
    v_and_b32 v186, v185, v31
    s_add_u32 m0, s5, 30720
    s_add_u32 s94, s4, 30720
    buffer_load_dwordx4 v1, s[48:51], s94 offen lds
    v_pk_fma_f32 v[128:129], v[80:81], v[176:177], v[128:129] op_sel_hi:[1,0,1]
    v_pk_fma_f32 v[130:131], v[82:83], v[176:177], v[130:131] op_sel_hi:[1,0,1]
    v_pk_mul_f32 v[128:129], v[128:129], v[176:177] op_sel:[0,1]
    v_pk_mul_f32 v[130:131], v[130:131], v[176:177] op_sel:[0,1]
    v_pk_fma_f32 v[132:133], v[84:85], v[176:177], v[132:133] op_sel_hi:[1,0,1]
    v_pk_fma_f32 v[134:135], v[86:87], v[176:177], v[134:135] op_sel_hi:[1,0,1]
    v_pk_mul_f32 v[132:133], v[132:133], v[176:177] op_sel:[0,1]
    v_pk_mul_f32 v[134:135], v[134:135], v[176:177] op_sel:[0,1]
    v_cvt_pk_bf16_f32 v212, v128, v129
    v_cvt_pk_bf16_f32 v213, v130, v131
    v_cvt_pk_bf16_f32 v214, v132, v133
    v_cvt_pk_bf16_f32 v215, v134, v135
    ds_write_b128 v17, v[212:215] offset:1024
    v_pk_fma_f32 v[160:161], v[32:33], v[184:185], v[160:161] op_sel_hi:[1,0,1]
    v_pk_fma_f32 v[162:163], v[34:35], v[184:185], v[162:163] op_sel_hi:[1,0,1]
    v_pk_mul_f32 v[160:161], v[160:161], v[186:187] op_sel_hi:[1,0]
    v_pk_mul_f32 v[162:163], v[162:163], v[186:187] op_sel_hi:[1,0]
    v_cvt_pk_bf16_f32 v220, v160, v161
    v_cvt_pk_bf16_f32 v221, v162, v163
    ds_write_b64 v19, v[220:221]
    s_add_u32 m0, s5, 31744
    s_add_u32 s94, s4, 31744
    buffer_load_dwordx4 v1, s[48:51], s94 offen lds
    v_pk_fma_f32 v[112:113], v[64:65], v[176:177], v[112:113] op_sel_hi:[1,0,1]
    v_pk_fma_f32 v[114:115], v[66:67], v[176:177], v[114:115] op_sel_hi:[1,0,1]
    v_pk_fma_f32 v[116:117], v[68:69], v[176:177], v[116:117] op_sel_hi:[1,0,1]
    v_pk_fma_f32 v[118:119], v[70:71], v[176:177], v[118:119] op_sel_hi:[1,0,1]
    v_cvt_pk_bf16_f32 v204, v112, v113
    v_cvt_pk_bf16_f32 v205, v114, v115
    v_cvt_pk_bf16_f32 v206, v116, v117
    v_cvt_pk_bf16_f32 v207, v118, v119
    s_waitcnt lgkmcnt(0)
    s_barrier
    ds_read_b128 v[222:225], v253
    ds_read_b64_tr_b16 v[226:227], v18 offset:0
    ds_read_b64_tr_b16 v[228:229], v18 offset:1024
    ds_read_b64_tr_b16 v[230:231], v18 offset:2048
    ds_read_b64_tr_b16 v[232:233], v18 offset:8
    ds_read_b64_tr_b16 v[234:235], v18 offset:1032
    ds_read_b64_tr_b16 v[236:237], v18 offset:2056
    s_add_u32 m0, s5, 32768
    s_add_u32 s94, s4, 32768
    buffer_load_dwordx4 v1, s[48:51], s94 offen lds
    v_pk_fma_f32 v[120:121], v[72:73], v[176:177], v[120:121] op_sel_hi:[1,0,1]
    v_pk_fma_f32 v[122:123], v[74:75], v[176:177], v[122:123] op_sel_hi:[1,0,1]
    v_pk_mul_f32 v[120:121], v[120:121], v[176:177] op_sel:[0,1]
    v_pk_mul_f32 v[122:123], v[122:123], v[176:177] op_sel:[0,1]
    v_pk_fma_f32 v[124:125], v[76:77], v[176:177], v[124:125] op_sel_hi:[1,0,1]
    v_pk_fma_f32 v[126:127], v[78:79], v[176:177], v[126:127] op_sel_hi:[1,0,1]
    v_pk_mul_f32 v[124:125], v[124:125], v[178:179] op_sel_hi:[1,0]
    v_pk_mul_f32 v[126:127], v[126:127], v[178:179] op_sel_hi:[1,0]
    v_cvt_pk_bf16_f32 v196, v120, v121
    v_cvt_pk_bf16_f32 v197, v122, v123
    v_cvt_pk_bf16_f32 v198, v124, v125
    v_cvt_pk_bf16_f32 v199, v126, v127
    s_add_u32 m0, s5, 33792
    s_add_u32 s94, s4, 33792
    buffer_load_dwordx4 v1, s[48:51], s94 offen lds
    v_pk_fma_f32 v[136:137], v[64:65], v[180:181], v[136:137] op_sel_hi:[1,0,1]
    v_pk_fma_f32 v[138:139], v[66:67], v[180:181], v[138:139] op_sel_hi:[1,0,1]
    v_pk_fma_f32 v[140:141], v[68:69], v[180:181], v[140:141] op_sel_hi:[1,0,1]
    v_pk_fma_f32 v[142:143], v[70:71], v[180:181], v[142:143] op_sel_hi:[1,0,1]
    v_cvt_pk_bf16_f32 v208, v136, v137
    v_cvt_pk_bf16_f32 v209, v138, v139
    v_cvt_pk_bf16_f32 v210, v140, v141
    v_cvt_pk_bf16_f32 v211, v142, v143
    s_nop 1
    v_mfma_f32_16x16x32_bf16 v[124:127], v[200:203], v[208:211], v[36:39]
    v_mfma_f32_16x16x32_bf16 v[120:123], v[196:199], v[208:211], v[40:43]
    v_mfma_f32_16x16x32_bf16 v[116:119], v[196:199], v[204:207], v[36:39]
    s_waitcnt lgkmcnt(6)
    v_mfma_f32_16x16x32_bf16 v[112:115], v[222:225], v[204:207], v[44:47]
    s_add_u32 m0, s5, 34816
    s_add_u32 s94, s4, 34816
    buffer_load_dwordx4 v1, s[48:51], s94 offen lds
    s_nop 0
    v_max3_f32 v129, v124, v125, v126
    v_max3_f32 v129, v129, v127, v120
    v_max3_f32 v129, v129, v121, v122
    v_max_f32 v129, v129, v123
    v_max3_f32 v128, v116, v117, v118
    v_max3_f32 v128, v128, v119, v112
    v_max3_f32 v128, v128, v113, v114
    v_max_f32 v128, v128, v115
    s_nop 1
    v_permlane32_swap_b32 v128, v129
    v_max_f32 v128, v128, v129
    v_mov_b32 v129, v128
    s_nop 1
    v_permlane16_swap_b32 v128, v129
    v_max_f32 v128, v128, v129
    v_mov_b32 v129, v128
    s_nop 1
    v_permlane32_swap_b32 v128, v129
    s_add_u32 m0, s5, 57344
    s_add_u32 s94, s4, 57344
    buffer_load_dwordx4 v1, s[48:51], s94 offen lds
    v_mul_f32 v130, v128, v179
    v_mul_f32 v132, v129, v183
    v_pk_fma_f32 v[112:113], v[112:113], v[178:179], v[130:131] op_sel:[0,1,0] op_sel_hi:[1,1,0] neg_lo:[0,0,1] neg_hi:[0,0,1]
    v_pk_fma_f32 v[114:115], v[114:115], v[178:179], v[130:131] op_sel:[0,1,0] op_sel_hi:[1,1,0] neg_lo:[0,0,1] neg_hi:[0,0,1]
    v_pk_fma_f32 v[116:117], v[116:117], v[178:179], v[130:131] op_sel:[0,1,0] op_sel_hi:[1,1,0] neg_lo:[0,0,1] neg_hi:[0,0,1]
    v_pk_fma_f32 v[118:119], v[118:119], v[178:179], v[130:131] op_sel:[0,1,0] op_sel_hi:[1,1,0] neg_lo:[0,0,1] neg_hi:[0,0,1]
    v_pk_fma_f32 v[120:121], v[120:121], v[182:183], v[132:133] op_sel:[0,1,0] op_sel_hi:[1,1,0] neg_lo:[0,0,1] neg_hi:[0,0,1]
    v_pk_fma_f32 v[122:123], v[122:123], v[182:183], v[132:133] op_sel:[0,1,0] op_sel_hi:[1,1,0] neg_lo:[0,0,1] neg_hi:[0,0,1]
    v_pk_fma_f32 v[124:125], v[124:125], v[182:183], v[132:133] op_sel:[0,1,0] op_sel_hi:[1,1,0] neg_lo:[0,0,1] neg_hi:[0,0,1]
    v_pk_fma_f32 v[126:127], v[126:127], v[182:183], v[132:133] op_sel:[0,1,0] op_sel_hi:[1,1,0] neg_lo:[0,0,1] neg_hi:[0,0,1]
    s_add_u32 m0, s5, 58368
    s_add_u32 s94, s4, 58368
    buffer_load_dwordx4 v1, s[48:51], s94 offen lds
    v_exp_f32 v112, v112
    v_exp_f32 v113, v113
    v_exp_f32 v114, v114
    v_exp_f32 v115, v115
    v_exp_f32 v116, v116
    v_exp_f32 v117, v117
    v_exp_f32 v118, v118
    v_exp_f32 v119, v119
    s_add_u32 m0, s5, 59392
    s_add_u32 s94, s4, 59392
    buffer_load_dwordx4 v1, s[48:51], s94 offen lds
    v_exp_f32 v120, v120
    v_exp_f32 v121, v121
    v_cvt_pk_bf16_f32 v136, v112, v113
    v_cvt_pk_bf16_f32 v137, v114, v115
    v_cvt_pk_bf16_f32 v138, v116, v117
    v_cvt_pk_bf16_f32 v139, v118, v119
    v_exp_f32 v122, v122
    v_exp_f32 v123, v123
    v_mfma_f32_16x16x32_bf16 v[160:163], a[232:235], v[136:139], 0
    v_exp_f32 v124, v124
    s_waitcnt lgkmcnt(4)
    v_mfma_f32_16x16x32_bf16 v[144:147], v[226:229], v[136:139], 0
    v_exp_f32 v125, v125
    s_waitcnt lgkmcnt(1)
    v_mfma_f32_16x16x32_bf16 v[148:151], v[232:235], v[136:139], 0
    v_exp_f32 v126, v126
    v_exp_f32 v127, v127
    v_cvt_pk_bf16_f32 v140, v120, v121
    v_cvt_pk_bf16_f32 v141, v122, v123
    v_cvt_pk_bf16_f32 v142, v124, v125
    v_cvt_pk_bf16_f32 v143, v126, v127
    s_nop 1
    v_mfma_f32_16x16x32_bf16 v[164:167], a[232:235], v[140:143], 0
    v_mfma_f32_16x16x32_bf16 v[152:155], v[228:231], v[140:143], 0
    s_waitcnt lgkmcnt(0)
    v_mfma_f32_16x16x32_bf16 v[156:159], v[234:237], v[140:143], 0
    s_add_u32 s89, s70, 16384
    s_lshl_b32 s88, s66, 4
    s_or_b32 s88, s88, s61
    v_rcp_f32 v160, v160
    s_nop 0
    v_rcp_f32 v164, v164
    v_mov_b32 v255, s88
    s_cmp_eq_u32 s63, 0
    v_pk_mul_f32 v[144:145], v[144:145], v[160:161] op_sel_hi:[1,0]
    v_pk_mul_f32 v[146:147], v[146:147], v[160:161] op_sel_hi:[1,0]
    v_pk_mul_f32 v[148:149], v[148:149], v[160:161] op_sel_hi:[1,0]
    v_pk_mul_f32 v[150:151], v[150:151], v[160:161] op_sel_hi:[1,0]
    v_cvt_pk_bf16_f32 v168, v144, v145
    v_cvt_pk_bf16_f32 v169, v146, v147
    v_cvt_pk_bf16_f32 v170, v148, v149
    v_cvt_pk_bf16_f32 v171, v150, v151
    s_cbranch_scc1 L_ofar_25
    buffer_store_dwordx2 v[168:169], v4, s[48:51], s70 offen
    buffer_store_dwordx2 v[170:171], v5, s[48:51], s70 offen
    v_pk_mul_f32 v[152:153], v[152:153], v[164:165] op_sel_hi:[1,0]
    v_pk_mul_f32 v[154:155], v[154:155], v[164:165] op_sel_hi:[1,0]
    v_pk_mul_f32 v[156:157], v[156:157], v[164:165] op_sel_hi:[1,0]
    v_pk_mul_f32 v[158:159], v[158:159], v[164:165] op_sel_hi:[1,0]
    v_cvt_pk_bf16_f32 v172, v152, v153
    v_cvt_pk_bf16_f32 v173, v154, v155
    v_cvt_pk_bf16_f32 v174, v156, v157
    v_cvt_pk_bf16_f32 v175, v158, v159
    buffer_store_dwordx2 v[172:173], v4, s[48:51], s89 offen
    buffer_store_dwordx2 v[174:175], v5, s[48:51], s89 offen
L_ostored_26:
    v_lshrrev_b32 v215, 8, v1
    v_lshrrev_b32 v214, 2, v16
    v_lshrrev_b32 v218, 2, v214
    v_sub_u32 v216, v214, v218
    v_add_u32 v216, 16, v216
    v_mul_u32_u24 v217, 224, v215
    v_add_u32 v217, 159744, v217
    v_lshl_add_u32 v216, v216, 1, v217
    v_lshl_add_u32 v217, v214, 1, v217
    v_and_b32 v218, 3, v214
    v_cmp_ne_u32 vcc, 3, v218
    s_nop 1
    v_cndmask_b32 v218, 0, -1, vcc
    v_and_b32 v214, v218, v20
    ds_read_u16 v204, v217 offset:0
    ds_read_u16 v205, v217 offset:56
    ds_read_u16 v206, v217 offset:112
    ds_read_u16 v207, v217 offset:168
    ds_read_u16 v208, v217 offset:896
    ds_read_u16 v209, v217 offset:952
    ds_read_u16 v210, v217 offset:1008
    ds_read_u16 v211, v217 offset:1064
    s_waitcnt lgkmcnt(6)
    v_lshl_or_b32 v204, v205, 16, v204
    v_accvgpr_write_b32 a242, v204
    s_waitcnt lgkmcnt(4)
    v_lshl_or_b32 v206, v207, 16, v206
    v_accvgpr_write_b32 a243, v206
    s_waitcnt lgkmcnt(2)
    v_lshl_or_b32 v208, v209, 16, v208
    v_and_b32 v208, v208, v20
    v_accvgpr_write_b32 a244, v208
    s_waitcnt lgkmcnt(0)
    v_lshl_or_b32 v210, v211, 16, v210
    v_and_b32 v210, v210, v20
    v_accvgpr_write_b32 a245, v210
    ds_read_u16 v204, v216 offset:0
    ds_read_u16 v205, v216 offset:56
    ds_read_u16 v206, v216 offset:112
    ds_read_u16 v207, v216 offset:168
    ds_read_u16 v208, v216 offset:896
    ds_read_u16 v209, v216 offset:952
    ds_read_u16 v210, v216 offset:1008
    ds_read_u16 v211, v216 offset:1064
    s_waitcnt lgkmcnt(6)
    v_lshl_or_b32 v204, v205, 16, v204
    v_and_b32 v204, v204, v218
    v_accvgpr_write_b32 a246, v204
    s_waitcnt lgkmcnt(4)
    v_lshl_or_b32 v206, v207, 16, v206
    v_and_b32 v206, v206, v218
    v_accvgpr_write_b32 a247, v206
    s_waitcnt lgkmcnt(2)
    v_lshl_or_b32 v208, v209, 16, v208
    v_and_b32 v208, v208, v214
    v_accvgpr_write_b32 a248, v208
    s_waitcnt lgkmcnt(0)
    v_lshl_or_b32 v210, v211, 16, v210
    v_and_b32 v210, v210, v214
    v_accvgpr_write_b32 a249, v210
    s_waitcnt vmcnt(0)
    s_cmp_eq_u32 s63, 0
    s_cbranch_scc1 L_pubslow_27
    s_mov_b64 exec, 1
    buffer_store_dword v255, off, s[48:51], s75
L_pubdone_28:
    s_mov_b64 exec, -1
    s_add_u32 m0, s5, 60416
    s_add_u32 s94, s4, 60416
    buffer_load_dwordx4 v1, s[48:51], s94 offen lds
    s_add_u32 m0, s5, 61440
    s_add_u32 s94, s4, 61440
    buffer_load_dwordx4 v1, s[48:51], s94 offen lds
    s_add_u32 m0, s5, 62464
    s_add_u32 s94, s4, 62464
    buffer_load_dwordx4 v1, s[48:51], s94 offen lds
    s_add_u32 m0, s5, 63488
    s_add_u32 s94, s4, 63488
    buffer_load_dwordx4 v1, s[48:51], s94 offen lds
    s_mov_b32 s65, 1
    s_mov_b64 s[24:25], s[32:33]
    s_mov_b32 s26, 401408
    s_branch L_p
L_p:
    s_waitcnt lgkmcnt(0)
    s_barrier
    s_cmp_eq_u32 s59, 7
    s_cbranch_scc1 L_pidle
    s_lshl_b32 s88, s66, 4
    s_or_b32 s88, s88, s61
    ds_read_b64_tr_b16 a[64:65], v7 offset:0
    ds_read_b64_tr_b16 a[66:67], v7 offset:2048
    ds_read_b64_tr_b16 a[68:69], v8 offset:0
    ds_read_b64_tr_b16 a[70:71], v8 offset:2048
    s_add_u32 m0, s6, 32768
    s_add_u32 s93, s7, 229376
    buffer_load_dwordx4 v246, s[24:27], s93 offen lds
    ds_read_b64_tr_b16 a[72:73], v9 offset:0
    ds_read_b64_tr_b16 a[74:75], v9 offset:2048
    ds_read_b64_tr_b16 a[76:77], v10 offset:0
    ds_read_b64_tr_b16 a[78:79], v10 offset:2048
    ds_read_b64_tr_b16 a[80:81], v7 offset:4096
    ds_read_b64_tr_b16 a[82:83], v7 offset:6144
    ds_read_b64_tr_b16 a[84:85], v8 offset:4096
    ds_read_b64_tr_b16 a[86:87], v8 offset:6144
    s_addk_i32 m0, 4096
    s_addk_i32 s93, 28672
    buffer_load_dwordx4 v246, s[24:27], s93 offen lds
    ds_read_b64_tr_b16 a[88:89], v9 offset:4096
    ds_read_b64_tr_b16 a[90:91], v9 offset:6144
    ds_read_b64_tr_b16 a[92:93], v10 offset:4096
    s_waitcnt lgkmcnt(14)
    ds_read_b64_tr_b16 a[94:95], v10 offset:6144
    s_waitcnt lgkmcnt(14)
    ds_read_b64_tr_b16 a[96:97], v7 offset:8192
    s_waitcnt lgkmcnt(14)
    ds_read_b64_tr_b16 a[98:99], v7 offset:10240
    s_waitcnt lgkmcnt(14)
    ds_read_b64_tr_b16 a[100:101], v8 offset:8192
    s_waitcnt lgkmcnt(14)
    ds_read_b64_tr_b16 a[102:103], v8 offset:10240
    s_addk_i32 m0, 4096
    s_addk_i32 s93, 28672
    buffer_load_dwordx4 v246, s[24:27], s93 offen lds
    s_waitcnt lgkmcnt(14)
    ds_read_b64_tr_b16 a[104:105], v9 offset:8192
    s_waitcnt lgkmcnt(14)
    ds_read_b64_tr_b16 a[106:107], v9 offset:10240
    s_waitcnt lgkmcnt(14)
    ds_read_b64_tr_b16 a[108:109], v10 offset:8192
    s_waitcnt lgkmcnt(14)
    ds_read_b64_tr_b16 a[110:111], v10 offset:10240
    s_waitcnt lgkmcnt(14)
    ds_read_b64_tr_b16 a[168:169], v7 offset:12288
    s_waitcnt lgkmcnt(14)
    ds_read_b64_tr_b16 a[170:171], v7 offset:14336
    s_waitcnt lgkmcnt(14)
    ds_read_b64_tr_b16 a[172:173], v8 offset:12288
    s_waitcnt lgkmcnt(14)
    ds_read_b64_tr_b16 a[174:175], v8 offset:14336
    s_addk_i32 m0, 4096
    s_addk_i32 s93, 28672
    buffer_load_dwordx4 v246, s[24:27], s93 offen lds
    s_waitcnt lgkmcnt(14)
    ds_read_b64_tr_b16 a[176:177], v9 offset:12288
    s_waitcnt lgkmcnt(14)
    ds_read_b64_tr_b16 a[178:179], v9 offset:14336
    s_waitcnt lgkmcnt(14)
    ds_read_b64_tr_b16 a[180:181], v10 offset:12288
    s_waitcnt lgkmcnt(14)
    ds_read_b64_tr_b16 a[182:183], v10 offset:14336
    buffer_load_dword v112, v16, s[48:51], s76 offen sc1
    s_waitcnt lgkmcnt(14)
    ds_read_b64_tr_b16 a[184:185], v7 offset:16384
    s_waitcnt lgkmcnt(14)
    ds_read_b64_tr_b16 a[186:187], v7 offset:18432
    s_waitcnt lgkmcnt(14)
    ds_read_b64_tr_b16 a[188:189], v8 offset:16384
    s_waitcnt lgkmcnt(14)
    ds_read_b64_tr_b16 a[190:191], v8 offset:18432
    s_addk_i32 m0, 4096
    s_addk_i32 s93, 28672
    buffer_load_dwordx4 v246, s[24:27], s93 offen lds
    s_waitcnt lgkmcnt(14)
    ds_read_b64_tr_b16 a[192:193], v9 offset:16384
    s_waitcnt lgkmcnt(14)
    ds_read_b64_tr_b16 a[194:195], v9 offset:18432
    s_waitcnt lgkmcnt(14)
    ds_read_b64_tr_b16 a[196:197], v10 offset:16384
    s_waitcnt lgkmcnt(14)
    ds_read_b64_tr_b16 a[198:199], v10 offset:18432
    s_waitcnt lgkmcnt(14)
    ds_read_b64_tr_b16 v[128:129], v7 offset:20480
    s_waitcnt lgkmcnt(14)
    ds_read_b64_tr_b16 v[130:131], v7 offset:22528
    s_waitcnt lgkmcnt(14)
    ds_read_b64_tr_b16 v[132:133], v8 offset:20480
    s_waitcnt lgkmcnt(14)
    ds_read_b64_tr_b16 v[134:135], v8 offset:22528
    s_addk_i32 m0, 4096
    s_addk_i32 s93, 28672
    buffer_load_dwordx4 v246, s[24:27], s93 offen lds
    s_waitcnt lgkmcnt(14)
    ds_read_b64_tr_b16 v[136:137], v9 offset:20480
    s_waitcnt lgkmcnt(14)
    ds_read_b64_tr_b16 v[138:139], v9 offset:22528
    s_waitcnt lgkmcnt(14)
    ds_read_b64_tr_b16 v[140:141], v10 offset:20480
    s_waitcnt lgkmcnt(14)
    ds_read_b64_tr_b16 v[142:143], v10 offset:22528
    s_waitcnt lgkmcnt(14)
    ds_read_b64_tr_b16 v[144:145], v7 offset:24576
    s_waitcnt lgkmcnt(14)
    ds_read_b64_tr_b16 v[146:147], v7 offset:26624
    s_waitcnt lgkmcnt(14)
    ds_read_b64_tr_b16 v[148:149], v8 offset:24576
    s_waitcnt lgkmcnt(14)
    ds_read_b64_tr_b16 v[150:151], v8 offset:26624
    s_waitcnt lgkmcnt(14)
    ds_read_b64_tr_b16 v[152:153], v9 offset:24576
    s_waitcnt lgkmcnt(14)
    ds_read_b64_tr_b16 v[154:155], v9 offset:26624
    s_waitcnt lgkmcnt(14)
    ds_read_b64_tr_b16 v[156:157], v10 offset:24576
    s_waitcnt lgkmcnt(14)
    ds_read_b64_tr_b16 v[158:159], v10 offset:26624
    s_waitcnt lgkmcnt(14)
    ds_read_b64_tr_b16 v[160:161], v7 offset:28672
    s_waitcnt lgkmcnt(14)
    ds_read_b64_tr_b16 v[162:163], v7 offset:30720
    s_waitcnt lgkmcnt(14)
    ds_read_b64_tr_b16 v[164:165], v8 offset:28672
    s_waitcnt lgkmcnt(14)
    ds_read_b64_tr_b16 v[166:167], v8 offset:30720
    s_waitcnt lgkmcnt(14)
    ds_read_b64_tr_b16 v[168:169], v9 offset:28672
    s_waitcnt lgkmcnt(14)
    ds_read_b64_tr_b16 v[170:171], v9 offset:30720
    s_waitcnt lgkmcnt(14)
    ds_read_b64_tr_b16 v[172:173], v10 offset:28672
    s_waitcnt lgkmcnt(14)
    ds_read_b64_tr_b16 v[174:175], v10 offset:30720
    s_waitcnt vmcnt(0)
    v_cmp_ne_u32 vcc, s88, v112
    s_cbranch_vccnz L_ppoll_29
L_ppass_30:
    buffer_load_dwordx4 a[0:3], v1, s[48:51], s73 offen offset:0 sc1
    buffer_load_dwordx4 a[4:7], v1, s[48:51], s73 offen offset:1024 sc1
    buffer_load_dwordx4 a[8:11], v1, s[48:51], s73 offen offset:2048 sc1
    buffer_load_dwordx4 a[12:15], v1, s[48:51], s73 offen offset:3072 sc1
    s_add_u32 s89, s73, 4096
    buffer_load_dwordx4 a[16:19], v1, s[48:51], s89 offen offset:0 sc1
    s_barrier
    s_waitcnt lgkmcnt(14)
    ds_read_b64_tr_b16 v[176:177], v7 offset:32768
    s_waitcnt lgkmcnt(14)
    ds_read_b64_tr_b16 v[178:179], v7 offset:34816
    s_waitcnt lgkmcnt(14)
    ds_read_b64_tr_b16 v[180:181], v8 offset:32768
    s_waitcnt lgkmcnt(14)
    ds_read_b64_tr_b16 v[182:183], v8 offset:34816
    s_waitcnt lgkmcnt(14)
    ds_read_b64_tr_b16 v[184:185], v9 offset:32768
    s_waitcnt lgkmcnt(14)
    ds_read_b64_tr_b16 v[186:187], v9 offset:34816
    s_waitcnt lgkmcnt(14)
    ds_read_b64_tr_b16 v[188:189], v10 offset:32768
    s_waitcnt lgkmcnt(14)
    ds_read_b64_tr_b16 v[190:191], v10 offset:34816
    s_waitcnt lgkmcnt(14)
    ds_read_b64_tr_b16 v[192:193], v7 offset:36864
    s_waitcnt lgkmcnt(14)
    ds_read_b64_tr_b16 v[194:195], v7 offset:38912
    s_waitcnt lgkmcnt(14)
    ds_read_b64_tr_b16 v[196:197], v8 offset:36864
    s_waitcnt lgkmcnt(14)
    ds_read_b64_tr_b16 v[198:199], v8 offset:38912
    s_waitcnt lgkmcnt(14)
    ds_read_b64_tr_b16 v[200:201], v9 offset:36864
    s_waitcnt lgkmcnt(14)
    ds_read_b64_tr_b16 v[202:203], v9 offset:38912
    s_waitcnt lgkmcnt(14)
    ds_read_b64_tr_b16 v[204:205], v10 offset:36864
    s_waitcnt lgkmcnt(14)
    ds_read_b64_tr_b16 v[206:207], v10 offset:38912
    s_waitcnt lgkmcnt(14)
    ds_read_b64_tr_b16 v[208:209], v7 offset:40960
    s_waitcnt lgkmcnt(14)
    ds_read_b64_tr_b16 v[210:211], v7 offset:43008
    s_waitcnt lgkmcnt(14)
    ds_read_b64_tr_b16 v[212:213], v8 offset:40960
    s_waitcnt lgkmcnt(14)
    ds_read_b64_tr_b16 v[214:215], v8 offset:43008
    s_waitcnt lgkmcnt(14)
    ds_read_b64_tr_b16 v[216:217], v9 offset:40960
    s_waitcnt lgkmcnt(14)
    ds_read_b64_tr_b16 v[218:219], v9 offset:43008
    s_waitcnt lgkmcnt(14)
    ds_read_b64_tr_b16 v[220:221], v10 offset:40960
    s_waitcnt lgkmcnt(14)
    ds_read_b64_tr_b16 v[222:223], v10 offset:43008
    s_waitcnt lgkmcnt(14)
    ds_read_b64_tr_b16 v[224:225], v7 offset:45056
    s_waitcnt lgkmcnt(14)
    ds_read_b64_tr_b16 v[226:227], v7 offset:47104
    s_waitcnt lgkmcnt(14)
    ds_read_b64_tr_b16 v[228:229], v8 offset:45056
    s_waitcnt lgkmcnt(14)
    ds_read_b64_tr_b16 v[230:231], v8 offset:47104
    s_waitcnt lgkmcnt(14)
    ds_read_b64_tr_b16 v[232:233], v9 offset:45056
    s_waitcnt lgkmcnt(14)
    ds_read_b64_tr_b16 v[234:235], v9 offset:47104
    s_waitcnt lgkmcnt(14)
    ds_read_b64_tr_b16 v[236:237], v10 offset:45056
    s_waitcnt lgkmcnt(14)
    ds_read_b64_tr_b16 v[238:239], v10 offset:47104
    s_waitcnt vmcnt(4)
    v_mfma_f32_16x16x32_bf16 v[48:51], a[64:67], a[0:3], v[48:51]
    buffer_load_dwordx4 a[20:23], v1, s[48:51], s89 offen offset:1024 sc1
    s_waitcnt lgkmcnt(14)
    ds_read_b64_tr_b16 a[64:65], v7 offset:49152
    v_mfma_f32_16x16x32_bf16 v[52:55], a[68:71], a[0:3], v[52:55]
    s_waitcnt lgkmcnt(14)
    ds_read_b64_tr_b16 a[66:67], v7 offset:51200
    s_waitcnt lgkmcnt(14)
    ds_read_b64_tr_b16 a[68:69], v8 offset:49152
    v_mfma_f32_16x16x32_bf16 v[56:59], a[72:75], a[0:3], v[56:59]
    s_waitcnt lgkmcnt(14)
    ds_read_b64_tr_b16 a[70:71], v8 offset:51200
    s_waitcnt lgkmcnt(14)
    ds_read_b64_tr_b16 a[72:73], v9 offset:49152
    v_mfma_f32_16x16x32_bf16 v[60:63], a[76:79], a[0:3], v[60:63]
    s_waitcnt vmcnt(4)
    s_waitcnt lgkmcnt(14)
    ds_read_b64_tr_b16 a[74:75], v9 offset:51200
    v_mfma_f32_16x16x32_bf16 v[48:51], a[80:83], a[4:7], v[48:51]
    buffer_load_dwordx4 a[24:27], v1, s[48:51], s89 offen offset:2048 sc1
    s_waitcnt lgkmcnt(14)
    ds_read_b64_tr_b16 a[76:77], v10 offset:49152
    v_mfma_f32_16x16x32_bf16 v[52:55], a[84:87], a[4:7], v[52:55]
    s_waitcnt lgkmcnt(14)
    ds_read_b64_tr_b16 a[78:79], v10 offset:51200
    s_waitcnt lgkmcnt(14)
    ds_read_b64_tr_b16 a[80:81], v7 offset:53248
    v_mfma_f32_16x16x32_bf16 v[56:59], a[88:91], a[4:7], v[56:59]
    s_waitcnt lgkmcnt(14)
    ds_read_b64_tr_b16 a[82:83], v7 offset:55296
    s_waitcnt lgkmcnt(14)
    ds_read_b64_tr_b16 a[84:85], v8 offset:53248
    v_mfma_f32_16x16x32_bf16 v[60:63], a[92:95], a[4:7], v[60:63]
    s_waitcnt vmcnt(4)
    s_waitcnt lgkmcnt(14)
    ds_read_b64_tr_b16 a[86:87], v8 offset:55296
    v_mfma_f32_16x16x32_bf16 v[48:51], a[96:99], a[8:11], v[48:51]
    buffer_load_dwordx4 a[28:31], v1, s[48:51], s89 offen offset:3072 sc1
    s_waitcnt lgkmcnt(14)
    ds_read_b64_tr_b16 a[88:89], v9 offset:53248
    v_mfma_f32_16x16x32_bf16 v[52:55], a[100:103], a[8:11], v[52:55]
    s_waitcnt lgkmcnt(14)
    ds_read_b64_tr_b16 a[90:91], v9 offset:55296
    s_waitcnt lgkmcnt(14)
    ds_read_b64_tr_b16 a[92:93], v10 offset:53248
    v_mfma_f32_16x16x32_bf16 v[56:59], a[104:107], a[8:11], v[56:59]
    s_waitcnt lgkmcnt(14)
    ds_read_b64_tr_b16 a[94:95], v10 offset:55296
    v_mfma_f32_16x16x32_bf16 v[60:63], a[108:111], a[8:11], v[60:63]
    s_waitcnt vmcnt(4)
    v_mfma_f32_16x16x32_bf16 v[48:51], a[168:171], a[12:15], v[48:51]
    s_add_u32 s89, s73, 8192
    buffer_load_dwordx4 a[32:35], v1, s[48:51], s89 offen offset:0 sc1
    v_mfma_f32_16x16x32_bf16 v[52:55], a[172:175], a[12:15], v[52:55]
    v_mfma_f32_16x16x32_bf16 v[56:59], a[176:179], a[12:15], v[56:59]
    v_mfma_f32_16x16x32_bf16 v[60:63], a[180:183], a[12:15], v[60:63]
    s_waitcnt vmcnt(4)
    v_mfma_f32_16x16x32_bf16 v[48:51], a[184:187], a[16:19], v[48:51]
    buffer_load_dwordx4 a[36:39], v1, s[48:51], s89 offen offset:1024 sc1
    v_mfma_f32_16x16x32_bf16 v[52:55], a[188:191], a[16:19], v[52:55]
    v_mfma_f32_16x16x32_bf16 v[56:59], a[192:195], a[16:19], v[56:59]
    v_mfma_f32_16x16x32_bf16 v[60:63], a[196:199], a[16:19], v[60:63]
    s_waitcnt vmcnt(4)
    v_mfma_f32_16x16x32_bf16 v[48:51], v[128:131], a[20:23], v[48:51]
    buffer_load_dwordx4 a[40:43], v1, s[48:51], s89 offen offset:2048 sc1
    v_mfma_f32_16x16x32_bf16 v[52:55], v[132:135], a[20:23], v[52:55]
    v_mfma_f32_16x16x32_bf16 v[56:59], v[136:139], a[20:23], v[56:59]
    v_mfma_f32_16x16x32_bf16 v[60:63], v[140:143], a[20:23], v[60:63]
    s_waitcnt vmcnt(4)
    v_mfma_f32_16x16x32_bf16 v[48:51], v[144:147], a[24:27], v[48:51]
    buffer_load_dwordx4 a[44:47], v1, s[48:51], s89 offen offset:3072 sc1
    v_mfma_f32_16x16x32_bf16 v[52:55], v[148:151], a[24:27], v[52:55]
    v_mfma_f32_16x16x32_bf16 v[56:59], v[152:155], a[24:27], v[56:59]
    v_mfma_f32_16x16x32_bf16 v[60:63], v[156:159], a[24:27], v[60:63]
    s_waitcnt vmcnt(4)
    v_mfma_f32_16x16x32_bf16 v[48:51], v[160:163], a[28:31], v[48:51]
    s_add_u32 s89, s73, 12288
    buffer_load_dwordx4 a[48:51], v1, s[48:51], s89 offen offset:0 sc1
    v_mfma_f32_16x16x32_bf16 v[52:55], v[164:167], a[28:31], v[52:55]
    v_mfma_f32_16x16x32_bf16 v[56:59], v[168:171], a[28:31], v[56:59]
    v_mfma_f32_16x16x32_bf16 v[60:63], v[172:175], a[28:31], v[60:63]
    s_waitcnt vmcnt(4)
    v_mfma_f32_16x16x32_bf16 v[48:51], v[176:179], a[32:35], v[48:51]
    buffer_load_dwordx4 a[52:55], v1, s[48:51], s89 offen offset:1024 sc1
    v_mfma_f32_16x16x32_bf16 v[52:55], v[180:183], a[32:35], v[52:55]
    v_mfma_f32_16x16x32_bf16 v[56:59], v[184:187], a[32:35], v[56:59]
    v_mfma_f32_16x16x32_bf16 v[60:63], v[188:191], a[32:35], v[60:63]
    s_waitcnt vmcnt(4)
    v_mfma_f32_16x16x32_bf16 v[48:51], v[192:195], a[36:39], v[48:51]
    v_mfma_f32_16x16x32_bf16 v[52:55], v[196:199], a[36:39], v[52:55]
    v_mfma_f32_16x16x32_bf16 v[56:59], v[200:203], a[36:39], v[56:59]
    v_mfma_f32_16x16x32_bf16 v[60:63], v[204:207], a[36:39], v[60:63]
    s_waitcnt vmcnt(3)
    v_mfma_f32_16x16x32_bf16 v[48:51], v[208:211], a[40:43], v[48:51]
    v_lshrrev_b32 v136, 2, v16
    v_lshrrev_b32 v137, 9, v1
    v_mfma_f32_16x16x32_bf16 v[52:55], v[212:215], a[40:43], v[52:55]
    v_xor_b32 v137, v137, v136
    v_and_b32 v137, 7, v137
    v_mfma_f32_16x16x32_bf16 v[56:59], v[216:219], a[40:43], v[56:59]
    v_lshlrev_b32 v137, 4, v137
    v_lshl_add_u32 v137, v136, 7, v137
    v_mfma_f32_16x16x32_bf16 v[60:63], v[220:223], a[40:43], v[60:63]
    s_waitcnt vmcnt(2)
    v_bfe_u32 v136, v1, 8, 1
    s_lshl_b32 s89, s58, 11
    v_mfma_f32_16x16x32_bf16 v[48:51], v[224:227], a[44:47], v[48:51]
    s_add_u32 s89, s89, 151552
    v_lshl_add_u32 v137, v136, 3, v137
    v_add_u32 v132, s89, v137
    v_mfma_f32_16x16x32_bf16 v[52:55], v[228:231], a[44:47], v[52:55]
    v_xor_b32 v133, 32, v132
    v_xor_b32 v134, 64, v132
    v_mfma_f32_16x16x32_bf16 v[56:59], v[232:235], a[44:47], v[56:59]
    v_xor_b32 v135, 96, v132
    v_lshrrev_b32 v136, 3, v1
    v_mfma_f32_16x16x32_bf16 v[60:63], v[236:239], a[44:47], v[60:63]
    s_waitcnt vmcnt(1) lgkmcnt(14)
    v_and_b32 v136, 0x70, v136
    v_xor_b32 v136, v136, v1
    v_mfma_f32_16x16x32_bf16 v[48:51], a[64:67], a[48:51], v[48:51]
    s_waitcnt lgkmcnt(12)
    v_add_u32 v120, s89, v136
    s_add_u32 s90, s85, 14336
    v_mfma_f32_16x16x32_bf16 v[52:55], a[68:71], a[48:51], v[52:55]
    s_waitcnt lgkmcnt(10)
    v_mfma_f32_16x16x32_bf16 v[56:59], a[72:75], a[48:51], v[56:59]
    s_waitcnt lgkmcnt(8)
    v_mfma_f32_16x16x32_bf16 v[60:63], a[76:79], a[48:51], v[60:63]
    s_waitcnt vmcnt(0) lgkmcnt(6)
    v_mfma_f32_16x16x32_bf16 v[48:51], a[80:83], a[52:55], v[48:51]
    s_waitcnt lgkmcnt(4)
    v_mfma_f32_16x16x32_bf16 v[52:55], a[84:87], a[52:55], v[52:55]
    s_waitcnt lgkmcnt(2)
    v_mfma_f32_16x16x32_bf16 v[56:59], a[88:91], a[52:55], v[56:59]
    s_waitcnt lgkmcnt(0)
    v_mfma_f32_16x16x32_bf16 v[60:63], a[92:95], a[52:55], v[60:63]
    s_nop 7
    s_cmp_eq_u32 s66, 4
    s_cbranch_scc1 L_final
L_pepi:
    v_cvt_pk_bf16_f32 v112, v48, v49
    v_cvt_pk_bf16_f32 v113, v50, v51
    v_cvt_pk_bf16_f32 v114, v52, v53
    v_cvt_pk_bf16_f32 v115, v54, v55
    buffer_store_dwordx4 v[112:115], v1, s[48:51], s71 offen
    v_cvt_pk_bf16_f32 v116, v56, v57
    v_cvt_pk_bf16_f32 v117, v58, v59
    v_cvt_pk_bf16_f32 v118, v60, v61
    v_cvt_pk_bf16_f32 v119, v62, v63
    buffer_store_dwordx4 v[116:119], v1, s[48:51], s71 offen offset:1024
    v_pk_add_f32 v[120:121], v[48:49], v[50:51]
    v_pk_mul_f32 v[122:123], v[48:49], v[48:49]
    v_pk_fma_f32 v[122:123], v[50:51], v[50:51], v[122:123]
    v_pk_add_f32 v[120:121], v[120:121], v[52:53]
    v_pk_fma_f32 v[122:123], v[52:53], v[52:53], v[122:123]
    v_pk_add_f32 v[120:121], v[120:121], v[54:55]
    v_pk_fma_f32 v[122:123], v[54:55], v[54:55], v[122:123]
    v_pk_add_f32 v[120:121], v[120:121], v[56:57]
    v_pk_fma_f32 v[122:123], v[56:57], v[56:57], v[122:123]
    v_pk_add_f32 v[120:121], v[120:121], v[58:59]
    v_pk_fma_f32 v[122:123], v[58:59], v[58:59], v[122:123]
    v_pk_add_f32 v[120:121], v[120:121], v[60:61]
    v_pk_fma_f32 v[122:123], v[60:61], v[60:61], v[122:123]
    v_pk_add_f32 v[120:121], v[120:121], v[62:63]
    v_pk_fma_f32 v[122:123], v[62:63], v[62:63], v[122:123]
    v_add_f32 v124, v120, v121
    v_add_f32 v125, v122, v123
    s_add_u32 s66, s66, 1
    s_lshl_b32 s88, s66, 4
    v_permlane32_swap_b32 v124, v125
    s_or_b32 s88, s88, s61
    v_add_f32 v124, v124, v125
    v_mov_b32 v125, v124
    v_mov_b32 v255, s88
    s_cmp_eq_u32 s65, 0
    v_permlane16_swap_b32 v124, v125
    s_cselect_b32 s84, s78, 0
    v_add_f32 v124, v124, v125
    v_mov_b32 v125, v124
    s_lshl_b32 s89, s59, 10
    s_add_u32 s89, s89, s77
    v_permlane32_swap_b32 v124, v125
    s_mov_b64 exec, 0xffff
    buffer_store_dwordx2 v[124:125], v26, s[48:51], s72 offen
    s_mov_b64 exec, -1
    s_cmp_eq_u32 s84, 0
    s_cbranch_scc0 L_nohalo_31
    s_cmp_ge_u32 s66, 3
    s_cbranch_scc1 L_pwb_33
L_pwbd_34:
    s_waitcnt vmcnt(0)
L_pub_32:
    s_cmp_eq_u32 s63, 0
    s_cbranch_scc1 L_pubslow_35
    s_mov_b64 exec, 1
    buffer_store_dword v255, off, s[48:51], s74
L_pubdone_36:
    s_mov_b64 exec, -1
L_pnext:
    s_cmp_eq_u32 s65, 1
    s_cbranch_scc1 L_qb
L_qa:
    v_mad_u32_u24 v112, v30, s66, v29
    buffer_load_dword v114, v14, s[48:51], 0 offen sc1
    ds_read_b128 a[216:219], v244 offset:4096
    ds_write_b128 v244, a[220:223] offset:4096
    ds_read_b128 a[220:223], v244 offset:5120
    ds_write_b128 v244, a[224:227] offset:5120
    ds_read_b128 a[224:227], v244 offset:6144
    ds_write_b128 v244, a[228:231] offset:6144
L_badone_44:
    s_waitcnt lgkmcnt(0)
    s_barrier
L_once_45:
    ds_read_b128 a[168:171], v1 offset:0
    ds_read_b128 a[172:175], v1 offset:1024
    ds_read_b128 a[176:179], v1 offset:28672
    ds_read_b128 a[180:183], v1 offset:29696
    ds_read_b128 a[184:187], v240 offset:0
    ds_read_b128 a[188:191], v240 offset:1024
    s_branch L_qchk_43
L_qpoll_37:
    s_waitcnt vmcnt(0)
    buffer_load_dword v114, v14, s[48:51], 0 offen sc1
L_qchk_43:
    s_cmp_eq_u32 s84, 0
    s_waitcnt vmcnt(0)
    s_cbranch_scc0 L_pend_39
L_nopend_40:
    v_xor_b32 v113, v114, v112
    v_cmp_ne_u32 vcc, 0, v113
    s_cbranch_vccnz L_qslow_41
L_qpass_38:
    s_add_u32 s89, s68, 0
    s_add_u32 s90, s68, 14336
    buffer_load_dwordx4 a[0:3], v1, s[48:51], s89 offen offset:0 sc1
    buffer_load_dwordx4 a[4:7], v1, s[48:51], s90 offen offset:0 sc1
    buffer_load_dwordx4 a[8:11], v1, s[48:51], s89 offen offset:1024 sc1
    buffer_load_dwordx4 a[12:15], v1, s[48:51], s90 offen offset:1024 sc1
    buffer_load_dwordx4 a[16:19], v1, s[48:51], s89 offen offset:2048 sc1
    buffer_load_dwordx4 a[20:23], v1, s[48:51], s90 offen offset:2048 sc1
    s_waitcnt vmcnt(5) lgkmcnt(5)
    v_mfma_f32_16x16x32_bf16 v[112:115], a[168:171], a[0:3], 0
    s_waitcnt vmcnt(4)
    buffer_load_dwordx4 a[24:27], v1, s[48:51], s89 offen offset:3072 sc1
    v_mfma_f32_16x16x32_bf16 v[136:139], a[168:171], a[4:7], 0
    s_waitcnt lgkmcnt(4)
    ds_read_b128 a[168:171], v1 offset:2048
    v_mfma_f32_16x16x32_bf16 v[116:119], a[172:175], a[0:3], 0
    v_mad_u32_u24 v195, v28, s66, v13
    v_mfma_f32_16x16x32_bf16 v[140:143], a[172:175], a[4:7], 0
    s_waitcnt lgkmcnt(4)
    ds_read_b128 a[172:175], v1 offset:3072
    v_mfma_f32_16x16x32_bf16 v[120:123], a[176:179], a[0:3], 0
    buffer_load_dwordx4 a[28:31], v1, s[48:51], s90 offen offset:3072 sc1
    v_mfma_f32_16x16x32_bf16 v[144:147], a[176:179], a[4:7], 0
    s_waitcnt lgkmcnt(4)
    ds_read_b128 a[176:179], v1 offset:30720
    v_mfma_f32_16x16x32_bf16 v[124:127], a[180:183], a[0:3], 0
    v_mfma_f32_16x16x32_bf16 v[148:151], a[180:183], a[4:7], 0
    s_waitcnt lgkmcnt(4)
    ds_read_b128 a[180:183], v1 offset:31744
    v_mfma_f32_16x16x32_bf16 v[128:131], a[184:187], a[0:3], 0
    v_mfma_f32_16x16x32_bf16 v[152:155], a[184:187], a[4:7], 0
    s_waitcnt lgkmcnt(4)
    ds_read_b128 a[184:187], v240 offset:2048
    s_add_u32 s89, s68, 4096
    v_mfma_f32_16x16x32_bf16 v[132:135], a[188:191], a[0:3], 0
    s_add_u32 s90, s68, 18432
    buffer_load_dwordx4 a[32:35], v1, s[48:51], s89 offen offset:0 sc1
    v_mfma_f32_16x16x32_bf16 v[156:159], a[188:191], a[4:7], 0
    s_waitcnt vmcnt(6) lgkmcnt(4)
    ds_read_b128 a[188:191], v240 offset:3072
    v_mfma_f32_16x16x32_bf16 v[112:115], a[168:171], a[8:11], v[112:115]
    s_waitcnt vmcnt(5)
    v_mfma_f32_16x16x32_bf16 v[136:139], a[168:171], a[12:15], v[136:139]
    s_waitcnt lgkmcnt(4)
    ds_read_b128 a[168:171], v1 offset:4096
    buffer_load_dwordx4 a[36:39], v1, s[48:51], s90 offen offset:0 sc1
    v_mfma_f32_16x16x32_bf16 v[116:119], a[172:175], a[8:11], v[116:119]
    v_mfma_f32_16x16x32_bf16 v[140:143], a[172:175], a[12:15], v[140:143]
    s_waitcnt lgkmcnt(4)
    ds_read_b128 a[172:175], v1 offset:5120
    ds_read_b128 a[0:3], v6 offset:0
    v_mfma_f32_16x16x32_bf16 v[120:123], a[176:179], a[8:11], v[120:123]
    ds_read_b128 a[4:7], v6 offset:2048
    v_mfma_f32_16x16x32_bf16 v[144:147], a[176:179], a[12:15], v[144:147]
    s_waitcnt lgkmcnt(6)
    ds_read_b128 a[176:179], v1 offset:32768
    v_mfma_f32_16x16x32_bf16 v[124:127], a[180:183], a[8:11], v[124:127]
    buffer_load_dwordx4 a[40:43], v1, s[48:51], s89 offen offset:1024 sc1
    v_mfma_f32_16x16x32_bf16 v[148:151], a[180:183], a[12:15], v[148:151]
    s_waitcnt lgkmcnt(6)
    ds_read_b128 a[180:183], v1 offset:33792
    v_mfma_f32_16x16x32_bf16 v[128:131], a[184:187], a[8:11], v[128:131]
    v_mfma_f32_16x16x32_bf16 v[152:155], a[184:187], a[12:15], v[152:155]
    s_waitcnt lgkmcnt(6)
    ds_read_b128 a[184:187], v240 offset:4096
    v_mfma_f32_16x16x32_bf16 v[132:135], a[188:191], a[8:11], v[132:135]
    buffer_load_dwordx4 a[44:47], v1, s[48:51], s90 offen offset:1024 sc1
    v_mfma_f32_16x16x32_bf16 v[156:159], a[188:191], a[12:15], v[156:159]
    s_waitcnt vmcnt(7) lgkmcnt(6)
    ds_read_b128 a[188:191], v240 offset:5120
    v_mfma_f32_16x16x32_bf16 v[112:115], a[168:171], a[16:19], v[112:115]
    s_waitcnt vmcnt(6)
    v_mfma_f32_16x16x32_bf16 v[136:139], a[168:171], a[20:23], v[136:139]
    s_waitcnt lgkmcnt(6)
    ds_read_b128 a[168:171], v1 offset:6144
    v_mfma_f32_16x16x32_bf16 v[116:119], a[172:175], a[16:19], v[116:119]
    v_mfma_f32_16x16x32_bf16 v[140:143], a[172:175], a[20:23], v[140:143]
    s_waitcnt lgkmcnt(4)
    ds_read_b128 a[172:175], v1 offset:7168
    buffer_load_dwordx4 a[48:51], v1, s[48:51], s89 offen offset:2048 sc1
    v_mfma_f32_16x16x32_bf16 v[120:123], a[176:179], a[16:19], v[120:123]
    ds_read_b128 a[8:11], v6 offset:4096
    v_mfma_f32_16x16x32_bf16 v[144:147], a[176:179], a[20:23], v[144:147]
    s_waitcnt lgkmcnt(5)
    ds_read_b128 a[176:179], v1 offset:34816
    v_mfma_f32_16x16x32_bf16 v[124:127], a[180:183], a[16:19], v[124:127]
    v_mfma_f32_16x16x32_bf16 v[148:151], a[180:183], a[20:23], v[148:151]
    s_waitcnt lgkmcnt(5)
    ds_read_b128 a[180:183], v1 offset:35840
    buffer_load_dwordx4 a[52:55], v1, s[48:51], s90 offen offset:2048 sc1
    v_mfma_f32_16x16x32_bf16 v[128:131], a[184:187], a[16:19], v[128:131]
    v_mfma_f32_16x16x32_bf16 v[152:155], a[184:187], a[20:23], v[152:155]
    s_waitcnt lgkmcnt(5)
    ds_read_b128 a[184:187], v240 offset:6144
    v_mfma_f32_16x16x32_bf16 v[132:135], a[188:191], a[16:19], v[132:135]
    buffer_load_dwordx2 v[164:165], v21, s[48:51], s69 offen offset:0 sc1
    v_mfma_f32_16x16x32_bf16 v[156:159], a[188:191], a[20:23], v[156:159]
    s_waitcnt vmcnt(8) lgkmcnt(5)
    ds_read_b128 a[188:191], v240 offset:7168
    v_mfma_f32_16x16x32_bf16 v[112:115], a[168:171], a[24:27], v[112:115]
    s_waitcnt vmcnt(7)
    buffer_load_dwordx2 v[166:167], v21, s[48:51], s69 offen offset:512 sc1
    buffer_load_dwordx4 a[56:59], v1, s[48:51], s89 offen offset:3072 sc1
    v_mfma_f32_16x16x32_bf16 v[136:139], a[168:171], a[28:31], v[136:139]
    s_waitcnt lgkmcnt(5)
    ds_read_b128 a[168:171], v1 offset:8192
    v_mfma_f32_16x16x32_bf16 v[116:119], a[172:175], a[24:27], v[116:119]
    v_mfma_f32_16x16x32_bf16 v[140:143], a[172:175], a[28:31], v[140:143]
    s_waitcnt lgkmcnt(4)
    ds_read_b128 a[172:175], v1 offset:9216
    ds_read_b128 a[12:15], v6 offset:6144
    v_mfma_f32_16x16x32_bf16 v[120:123], a[176:179], a[24:27], v[120:123]
    buffer_load_dwordx4 a[60:63], v1, s[48:51], s90 offen offset:3072 sc1
    v_mfma_f32_16x16x32_bf16 v[144:147], a[176:179], a[28:31], v[144:147]
    s_waitcnt lgkmcnt(5)
    ds_read_b128 a[176:179], v1 offset:36864
    v_mfma_f32_16x16x32_bf16 v[124:127], a[180:183], a[24:27], v[124:127]
    v_mfma_f32_16x16x32_bf16 v[148:151], a[180:183], a[28:31], v[148:151]
    s_waitcnt lgkmcnt(5)
    ds_read_b128 a[180:183], v1 offset:37888
    buffer_load_dwordx2 v[168:169], v21, s[48:51], s69 offen offset:1024 sc1
    v_mfma_f32_16x16x32_bf16 v[128:131], a[184:187], a[24:27], v[128:131]
    v_mfma_f32_16x16x32_bf16 v[152:155], a[184:187], a[28:31], v[152:155]
    s_waitcnt lgkmcnt(5)
    ds_read_b128 a[184:187], v240 offset:8192
    buffer_load_dwordx2 v[170:171], v21, s[48:51], s69 offen offset:1536 sc1
    v_mfma_f32_16x16x32_bf16 v[132:135], a[188:191], a[24:27], v[132:135]
    s_add_u32 s89, s68, 8192
    s_add_u32 s90, s68, 22528
    buffer_load_dwordx4 a[64:67], v1, s[48:51], s89 offen offset:0 sc1
    v_mfma_f32_16x16x32_bf16 v[156:159], a[188:191], a[28:31], v[156:159]
    s_waitcnt vmcnt(12) lgkmcnt(5)
    ds_read_b128 a[188:191], v240 offset:9216
    v_mfma_f32_16x16x32_bf16 v[112:115], a[168:171], a[32:35], v[112:115]
    s_waitcnt vmcnt(11)
    v_mfma_f32_16x16x32_bf16 v[136:139], a[168:171], a[36:39], v[136:139]
    s_waitcnt lgkmcnt(5)
    ds_read_b128 a[168:171], v1 offset:10240
    buffer_load_dwordx4 a[68:71], v1, s[48:51], s90 offen offset:0 sc1
    v_mfma_f32_16x16x32_bf16 v[116:119], a[172:175], a[32:35], v[116:119]
    v_mfma_f32_16x16x32_bf16 v[140:143], a[172:175], a[36:39], v[140:143]
    s_waitcnt lgkmcnt(4)
    ds_read_b128 a[172:175], v1 offset:11264
    ds_read_b128 a[16:19], v6 offset:8192
    v_mfma_f32_16x16x32_bf16 v[120:123], a[176:179], a[32:35], v[120:123]
    ds_read_b128 a[20:23], v6 offset:10240
    v_mfma_f32_16x16x32_bf16 v[144:147], a[176:179], a[36:39], v[144:147]
    s_waitcnt lgkmcnt(6)
    ds_read_b128 a[176:179], v1 offset:38912
    v_mfma_f32_16x16x32_bf16 v[124:127], a[180:183], a[32:35], v[124:127]
    buffer_load_dwordx4 a[72:75], v1, s[48:51], s89 offen offset:1024 sc1
    v_mfma_f32_16x16x32_bf16 v[148:151], a[180:183], a[36:39], v[148:151]
    s_waitcnt lgkmcnt(6)
    ds_read_b128 a[180:183], v1 offset:39936
    v_mfma_f32_16x16x32_bf16 v[128:131], a[184:187], a[32:35], v[128:131]
    buffer_load_dword v194, v252, s[48:51], 0 offen sc1
    v_mfma_f32_16x16x32_bf16 v[152:155], a[184:187], a[36:39], v[152:155]
    s_waitcnt lgkmcnt(6)
    ds_read_b128 a[184:187], v240 offset:10240
    v_mfma_f32_16x16x32_bf16 v[132:135], a[188:191], a[32:35], v[132:135]
    buffer_load_dwordx4 a[76:79], v1, s[48:51], s90 offen offset:1024 sc1
    v_mfma_f32_16x16x32_bf16 v[156:159], a[188:191], a[36:39], v[156:159]
    s_waitcnt vmcnt(14) lgkmcnt(6)
    ds_read_b128 a[188:191], v240 offset:11264
    v_mfma_f32_16x16x32_bf16 v[112:115], a[168:171], a[40:43], v[112:115]
    s_waitcnt vmcnt(13)
    v_mfma_f32_16x16x32_bf16 v[136:139], a[168:171], a[44:47], v[136:139]
    s_waitcnt lgkmcnt(6)
    ds_read_b128 a[168:171], v1 offset:12288
    v_mfma_f32_16x16x32_bf16 v[116:119], a[172:175], a[40:43], v[116:119]
    v_mfma_f32_16x16x32_bf16 v[140:143], a[172:175], a[44:47], v[140:143]
    s_waitcnt lgkmcnt(4)
    ds_read_b128 a[172:175], v1 offset:13312
    buffer_load_dwordx4 a[80:83], v1, s[48:51], s89 offen offset:2048 sc1
    v_mfma_f32_16x16x32_bf16 v[120:123], a[176:179], a[40:43], v[120:123]
    ds_read_b128 a[24:27], v6 offset:12288
    v_mfma_f32_16x16x32_bf16 v[144:147], a[176:179], a[44:47], v[144:147]
    s_waitcnt lgkmcnt(5)
    ds_read_b128 a[176:179], v1 offset:40960
    v_mfma_f32_16x16x32_bf16 v[124:127], a[180:183], a[40:43], v[124:127]
    v_mfma_f32_16x16x32_bf16 v[148:151], a[180:183], a[44:47], v[148:151]
    s_waitcnt lgkmcnt(5)
    ds_read_b128 a[180:183], v1 offset:41984
    buffer_load_dwordx4 a[84:87], v1, s[48:51], s90 offen offset:2048 sc1
    v_mfma_f32_16x16x32_bf16 v[128:131], a[184:187], a[40:43], v[128:131]
    v_mfma_f32_16x16x32_bf16 v[152:155], a[184:187], a[44:47], v[152:155]
    s_waitcnt lgkmcnt(5)
    ds_read_b128 a[184:187], v240 offset:12288
    v_mfma_f32_16x16x32_bf16 v[132:135], a[188:191], a[40:43], v[132:135]
    v_mfma_f32_16x16x32_bf16 v[156:159], a[188:191], a[44:47], v[156:159]
    s_waitcnt vmcnt(14) lgkmcnt(5)
    ds_read_b128 a[188:191], v240 offset:13312
    v_mfma_f32_16x16x32_bf16 v[112:115], a[168:171], a[48:51], v[112:115]
    s_waitcnt vmcnt(13)
    buffer_load_dwordx4 a[88:91], v1, s[48:51], s89 offen offset:3072 sc1
    v_mfma_f32_16x16x32_bf16 v[136:139], a[168:171], a[52:55], v[136:139]
    s_waitcnt lgkmcnt(5)
    ds_read_b128 a[168:171], v1 offset:14336
    v_mfma_f32_16x16x32_bf16 v[116:119], a[172:175], a[48:51], v[116:119]
    v_mfma_f32_16x16x32_bf16 v[140:143], a[172:175], a[52:55], v[140:143]
    s_waitcnt lgkmcnt(4)
    ds_read_b128 a[172:175], v1 offset:15360
    ds_read_b128 a[28:31], v6 offset:14336
    v_mfma_f32_16x16x32_bf16 v[120:123], a[176:179], a[48:51], v[120:123]
    buffer_load_dwordx4 a[92:95], v1, s[48:51], s90 offen offset:3072 sc1
    v_mfma_f32_16x16x32_bf16 v[144:147], a[176:179], a[52:55], v[144:147]
    s_waitcnt lgkmcnt(5)
    ds_read_b128 a[176:179], v1 offset:43008
    v_mfma_f32_16x16x32_bf16 v[124:127], a[180:183], a[48:51], v[124:127]
    s_waitcnt vmcnt(13)
    v_and_b32 v166, v166, v20
    s_waitcnt vmcnt(9)
    v_and_b32 v170, v170, v20
    v_mfma_f32_16x16x32_bf16 v[148:151], a[180:183], a[52:55], v[148:151]
    s_waitcnt lgkmcnt(5)
    ds_read_b128 a[180:183], v1 offset:44032
    v_and_b32 v167, v167, v20
    v_mfma_f32_16x16x32_bf16 v[128:131], a[184:187], a[48:51], v[128:131]
    v_and_b32 v171, v171, v20
    v_add_f32 v164, v164, v166
    v_mfma_f32_16x16x32_bf16 v[152:155], a[184:187], a[52:55], v[152:155]
    s_waitcnt lgkmcnt(5)
    ds_read_b128 a[184:187], v240 offset:14336
    s_add_u32 s89, s68, 12288
    v_mfma_f32_16x16x32_bf16 v[132:135], a[188:191], a[48:51], v[132:135]
    s_add_u32 s90, s68, 26624
    buffer_load_dwordx4 a[96:99], v1, s[48:51], s89 offen offset:0 sc1
    v_add_f32 v168, v168, v170
    v_mfma_f32_16x16x32_bf16 v[156:159], a[188:191], a[52:55], v[156:159]
    s_waitcnt lgkmcnt(5)
    ds_read_b128 a[188:191], v240 offset:15360
    v_add_f32 v165, v165, v167
    v_mfma_f32_16x16x32_bf16 v[112:115], a[168:171], a[56:59], v[112:115]
    v_add_f32 v169, v169, v171
    v_mfma_f32_16x16x32_bf16 v[136:139], a[168:171], a[60:63], v[136:139]
    s_waitcnt lgkmcnt(5)
    ds_read_b128 a[168:171], v1 offset:16384
    buffer_load_dwordx4 a[100:103], v1, s[48:51], s90 offen offset:0 sc1
    v_mfma_f32_16x16x32_bf16 v[116:119], a[172:175], a[56:59], v[116:119]
    v_permlane32_swap_b32 v164, v165
    v_mfma_f32_16x16x32_bf16 v[140:143], a[172:175], a[60:63], v[140:143]
    s_waitcnt lgkmcnt(4)
    ds_read_b128 a[172:175], v1 offset:17408
    ds_read_b128 a[32:35], v6 offset:16384
    v_mfma_f32_16x16x32_bf16 v[120:123], a[176:179], a[56:59], v[120:123]
    v_permlane32_swap_b32 v168, v169
    v_mfma_f32_16x16x32_bf16 v[144:147], a[176:179], a[60:63], v[144:147]
    s_waitcnt lgkmcnt(5)
    ds_read_b128 a[176:179], v1 offset:45056
    v_add_f32 v164, v164, v165
    v_mfma_f32_16x16x32_bf16 v[124:127], a[180:183], a[56:59], v[124:127]
    buffer_load_dwordx4 a[104:107], v1, s[48:51], s89 offen offset:1024 sc1
    v_add_f32 v168, v168, v169
    v_mfma_f32_16x16x32_bf16 v[148:151], a[180:183], a[60:63], v[148:151]
    s_waitcnt lgkmcnt(5)
    ds_read_b128 a[180:183], v1 offset:46080
    v_mov_b32 v165, v164
    v_mfma_f32_16x16x32_bf16 v[128:131], a[184:187], a[56:59], v[128:131]
    v_mov_b32 v169, v168
    v_mfma_f32_16x16x32_bf16 v[152:155], a[184:187], a[60:63], v[152:155]
    s_waitcnt lgkmcnt(5)
    ds_read_b128 a[184:187], v240 offset:16384
    v_mfma_f32_16x16x32_bf16 v[132:135], a[188:191], a[56:59], v[132:135]
    buffer_load_dwordx4 a[108:111], v1, s[48:51], s90 offen offset:1024 sc1
    v_mfma_f32_16x16x32_bf16 v[156:159], a[188:191], a[60:63], v[156:159]
    s_waitcnt vmcnt(12) lgkmcnt(5)
    ds_read_b128 a[188:191], v240 offset:17408
    v_mfma_f32_16x16x32_bf16 v[112:115], a[168:171], a[64:67], v[112:115]
    s_waitcnt vmcnt(11)
    s_waitcnt vmcnt(9)
    v_cmp_ne_u32 vcc, v195, v194
    s_cbranch_vccnz L_hslow_46
L_hback_47:
    s_lshl_b32 s88, s58, 11
    v_mfma_f32_16x16x32_bf16 v[136:139], a[168:171], a[68:71], v[136:139]
    s_waitcnt lgkmcnt(5)
    ds_read_b128 a[168:171], v1 offset:18432
    s_add_u32 m0, s88, 151552
    v_mfma_f32_16x16x32_bf16 v[116:119], a[172:175], a[64:67], v[116:119]
    s_add_u32 s88, s88, s77
    buffer_load_dwordx4 v24, s[48:51], s88 offen offset:0 sc1 lds
    buffer_load_dwordx4 v24, s[48:51], s88 offen offset:1024 sc1 lds
    v_mfma_f32_16x16x32_bf16 v[140:143], a[172:175], a[68:71], v[140:143]
    s_waitcnt lgkmcnt(4)
    ds_read_b128 a[172:175], v1 offset:19456
    s_add_u32 s88, s77, 14336
    v_mfma_f32_16x16x32_bf16 v[120:123], a[176:179], a[64:67], v[120:123]
    buffer_load_dwordx2 v[172:173], v25, s[48:51], s88 offen offset:0 sc1
    buffer_load_dwordx2 v[174:175], v25, s[48:51], s88 offen offset:512 sc1
    v_mfma_f32_16x16x32_bf16 v[144:147], a[176:179], a[68:71], v[144:147]
    s_waitcnt lgkmcnt(4)
    ds_read_b128 a[176:179], v1 offset:47104
    v_add_u32 v194, 151552, v243
    v_mfma_f32_16x16x32_bf16 v[124:127], a[180:183], a[64:67], v[124:127]
    ds_read_b128 a[36:39], v6 offset:18432
    ds_read_b128 a[40:43], v6 offset:20480
    v_mfma_f32_16x16x32_bf16 v[148:151], a[180:183], a[68:71], v[148:151]
    s_waitcnt lgkmcnt(6)
    ds_read_b128 a[180:183], v1 offset:48128
    v_mfma_f32_16x16x32_bf16 v[128:131], a[184:187], a[64:67], v[128:131]
    v_permlane16_swap_b32 v164, v165
    v_mfma_f32_16x16x32_bf16 v[152:155], a[184:187], a[68:71], v[152:155]
    s_waitcnt lgkmcnt(6)
    ds_read_b128 a[184:187], v240 offset:18432
    v_mfma_f32_16x16x32_bf16 v[132:135], a[188:191], a[64:67], v[132:135]
    v_permlane16_swap_b32 v168, v169
    v_mfma_f32_16x16x32_bf16 v[156:159], a[188:191], a[68:71], v[156:159]
    s_waitcnt lgkmcnt(6)
    ds_read_b128 a[188:191], v240 offset:19456
    v_add_f32 v164, v164, v165
    v_mfma_f32_16x16x32_bf16 v[112:115], a[168:171], a[72:75], v[112:115]
    s_waitcnt vmcnt(12)
    v_add_f32 v168, v168, v169
    v_mov_b32 v165, v164
    v_mfma_f32_16x16x32_bf16 v[136:139], a[168:171], a[76:79], v[136:139]
    s_waitcnt lgkmcnt(6)
    ds_read_b128 a[168:171], v1 offset:20480
    v_mov_b32 v169, v168
    v_mfma_f32_16x16x32_bf16 v[116:119], a[172:175], a[72:75], v[116:119]
    v_permlane32_swap_b32 v164, v165
    v_mfma_f32_16x16x32_bf16 v[140:143], a[172:175], a[76:79], v[140:143]
    s_waitcnt lgkmcnt(6)
    ds_read_b128 a[172:175], v1 offset:21504
    ds_read_b128 a[44:47], v6 offset:22528
    v_mfma_f32_16x16x32_bf16 v[120:123], a[176:179], a[72:75], v[120:123]
    v_permlane32_swap_b32 v168, v169
    v_mfma_f32_16x16x32_bf16 v[144:147], a[176:179], a[76:79], v[144:147]
    s_waitcnt lgkmcnt(5)
    ds_read_b128 a[176:179], v1 offset:49152
    v_mul_f32 v176, 0xbb124925, v164
    v_mfma_f32_16x16x32_bf16 v[124:127], a[180:183], a[72:75], v[124:127]
    v_mul_f32 v180, 0xbb124925, v168
    v_mul_f32 v188, 0x3b124925, v165
    v_mfma_f32_16x16x32_bf16 v[148:151], a[180:183], a[76:79], v[148:151]
    s_waitcnt lgkmcnt(5)
    ds_read_b128 a[180:183], v1 offset:50176
    v_mul_f32 v190, 0x3b124925, v169
    v_mfma_f32_16x16x32_bf16 v[128:131], a[184:187], a[72:75], v[128:131]
    v_fma_f32 v188, -v176, v176, v188
    v_fma_f32 v190, -v180, v180, v190
    v_mfma_f32_16x16x32_bf16 v[152:155], a[184:187], a[76:79], v[152:155]
    s_waitcnt lgkmcnt(5)
    ds_read_b128 a[184:187], v240 offset:20480
    v_max_f32 v188, 0, v188
    v_mfma_f32_16x16x32_bf16 v[132:135], a[188:191], a[72:75], v[132:135]
    v_max_f32 v190, 0, v190
    v_add_f32 v188, 0x3727c5ac, v188
    v_mfma_f32_16x16x32_bf16 v[156:159], a[188:191], a[76:79], v[156:159]
    s_waitcnt vmcnt(11) lgkmcnt(5)
    ds_read_b128 a[188:191], v240 offset:21504
    v_add_f32 v190, 0x3727c5ac, v190
    v_mfma_f32_16x16x32_bf16 v[112:115], a[168:171], a[80:83], v[112:115]
    s_waitcnt vmcnt(10)
    v_rsq_f32 v177, v188
    v_mfma_f32_16x16x32_bf16 v[136:139], a[168:171], a[84:87], v[136:139]
    s_waitcnt lgkmcnt(5)
    ds_read_b128 a[168:171], v1 offset:22528
    v_mfma_f32_16x16x32_bf16 v[116:119], a[172:175], a[80:83], v[116:119]
    s_add_u32 m0, s6, 0
    s_add_u32 s93, s7, 0
    buffer_load_dwordx4 v246, s[32:35], s93 offen lds
    v_mfma_f32_16x16x32_bf16 v[140:143], a[172:175], a[84:87], v[140:143]
    s_waitcnt lgkmcnt(4)
    ds_read_b128 a[172:175], v1 offset:23552
    ds_read_b128 a[48:51], v6 offset:24576
    v_mfma_f32_16x16x32_bf16 v[120:123], a[176:179], a[80:83], v[120:123]
    v_rsq_f32 v181, v190
    v_mfma_f32_16x16x32_bf16 v[144:147], a[176:179], a[84:87], v[144:147]
    s_waitcnt lgkmcnt(5)
    ds_read_b128 a[176:179], v1 offset:51200
    v_and_b32 v178, v177, v20
    v_mfma_f32_16x16x32_bf16 v[124:127], a[180:183], a[80:83], v[124:127]
    v_and_b32 v182, v181, v20
    v_mul_f32 v179, 0x3e8b97f6, v177
    v_mfma_f32_16x16x32_bf16 v[148:151], a[180:183], a[84:87], v[148:151]
    s_waitcnt lgkmcnt(5)
    ds_read_b128 a[180:183], v1 offset:52224
    s_addk_i32 m0, 4096
    v_mfma_f32_16x16x32_bf16 v[128:131], a[184:187], a[80:83], v[128:131]
    s_addk_i32 s93, 28672
    buffer_load_dwordx4 v246, s[32:35], s93 offen lds
    v_mul_f32 v183, 0x3e8b97f6, v181
    v_mfma_f32_16x16x32_bf16 v[152:155], a[184:187], a[84:87], v[152:155]
    s_waitcnt lgkmcnt(5)
    ds_read_b128 a[184:187], v240 offset:22528
    v_mfma_f32_16x16x32_bf16 v[132:135], a[188:191], a[80:83], v[132:135]
    v_mfma_f32_16x16x32_bf16 v[156:159], a[188:191], a[84:87], v[156:159]
    s_waitcnt vmcnt(11) lgkmcnt(5)
    ds_read_b128 a[188:191], v240 offset:23552
    v_mfma_f32_16x16x32_bf16 v[112:115], a[168:171], a[88:91], v[112:115]
    s_waitcnt vmcnt(10)
    s_addk_i32 m0, 4096
    s_addk_i32 s93, 28672
    v_mfma_f32_16x16x32_bf16 v[136:139], a[168:171], a[92:95], v[136:139]
    s_waitcnt lgkmcnt(5)
    ds_read_b128 a[168:171], v1 offset:24576
    buffer_load_dwordx4 v246, s[32:35], s93 offen lds
    v_mfma_f32_16x16x32_bf16 v[116:119], a[172:175], a[88:91], v[116:119]
    v_mfma_f32_16x16x32_bf16 v[140:143], a[172:175], a[92:95], v[140:143]
    s_waitcnt lgkmcnt(4)
    ds_read_b128 a[172:175], v1 offset:25600
    ds_read_b128 a[52:55], v6 offset:26624
    v_mfma_f32_16x16x32_bf16 v[120:123], a[176:179], a[88:91], v[120:123]
    v_mfma_f32_16x16x32_bf16 v[144:147], a[176:179], a[92:95], v[144:147]
    s_waitcnt lgkmcnt(5)
    ds_read_b128 a[176:179], v1 offset:53248
    ds_read_b128 a[192:195], v1 offset:55296
    v_mfma_f32_16x16x32_bf16 v[124:127], a[180:183], a[88:91], v[124:127]
    s_addk_i32 m0, 4096
    s_addk_i32 s93, 28672
    buffer_load_dwordx4 v246, s[32:35], s93 offen lds
    v_mfma_f32_16x16x32_bf16 v[148:151], a[180:183], a[92:95], v[148:151]
    s_waitcnt lgkmcnt(6)
    ds_read_b128 a[180:183], v1 offset:54272
    ds_read_b128 a[196:199], v1 offset:56320
    v_mfma_f32_16x16x32_bf16 v[128:131], a[184:187], a[88:91], v[128:131]
    v_mfma_f32_16x16x32_bf16 v[152:155], a[184:187], a[92:95], v[152:155]
    s_waitcnt lgkmcnt(7)
    ds_read_b128 a[184:187], v240 offset:24576
    v_mfma_f32_16x16x32_bf16 v[132:135], a[188:191], a[88:91], v[132:135]
    s_addk_i32 m0, 4096
    s_addk_i32 s93, 28672
    buffer_load_dwordx4 v246, s[32:35], s93 offen lds
    v_mfma_f32_16x16x32_bf16 v[156:159], a[188:191], a[92:95], v[156:159]
    s_waitcnt vmcnt(11) lgkmcnt(4)
    ds_read_b128 a[188:191], v240 offset:25600
    v_mfma_f32_16x16x32_bf16 v[144:147], a[176:179], a[100:103], v[144:147]
    s_waitcnt vmcnt(5)
    v_and_b32 v174, v174, v20
    v_and_b32 v175, v175, v20
    v_mfma_f32_16x16x32_bf16 v[120:123], a[176:179], a[96:99], v[120:123]
    s_waitcnt lgkmcnt(3)
    ds_read_b128 a[176:179], v240 offset:26624
    v_add_f32 v172, v172, v174
    v_mfma_f32_16x16x32_bf16 v[148:151], a[180:183], a[100:103], v[148:151]
    v_add_f32 v173, v173, v175
    v_mfma_f32_16x16x32_bf16 v[124:127], a[180:183], a[96:99], v[124:127]
    s_addk_i32 m0, 4096
    ds_read_b128 a[180:183], v240 offset:27648
    s_addk_i32 s93, 28672
    v_mfma_f32_16x16x32_bf16 v[144:147], a[192:195], a[108:111], v[144:147]
    buffer_load_dwordx4 v246, s[32:35], s93 offen lds
    v_mfma_f32_16x16x32_bf16 v[120:123], a[192:195], a[104:107], v[120:123]
    s_waitcnt lgkmcnt(4)
    ds_read_b128 a[192:195], v1 offset:26624
    v_mfma_f32_16x16x32_bf16 v[148:151], a[196:199], a[108:111], v[148:151]
    v_permlane32_swap_b32 v172, v173
    v_mfma_f32_16x16x32_bf16 v[124:127], a[196:199], a[104:107], v[124:127]
    s_waitcnt lgkmcnt(4)
    ds_read_b128 a[196:199], v1 offset:27648
    v_add_f32 v172, v172, v173
    v_mfma_f32_16x16x32_bf16 v[152:155], a[184:187], a[100:103], v[152:155]
    s_addk_i32 m0, 4096
    s_addk_i32 s93, 28672
    buffer_load_dwordx4 v246, s[32:35], s93 offen lds
    v_mfma_f32_16x16x32_bf16 v[128:131], a[184:187], a[96:99], v[128:131]
    s_waitcnt lgkmcnt(4)
    v_fma_f32 v144, v72, v180, v144
    v_fma_f32 v145, v73, v180, v145
    v_mfma_f32_16x16x32_bf16 v[156:159], a[188:191], a[100:103], v[156:159]
    v_fma_f32 v146, v74, v180, v146
    v_fma_f32 v147, v75, v180, v147
    v_mfma_f32_16x16x32_bf16 v[132:135], a[188:191], a[96:99], v[132:135]
    s_waitcnt lgkmcnt(3)
    v_mul_f32 v144, v144, v181
    v_mul_f32 v145, v145, v181
    v_mfma_f32_16x16x32_bf16 v[152:155], a[176:179], a[108:111], v[152:155]
    v_mul_f32 v146, v146, v181
    v_mul_f32 v147, v147, v181
    v_mfma_f32_16x16x32_bf16 v[128:131], a[176:179], a[104:107], v[128:131]
    s_waitcnt lgkmcnt(2)
    s_waitcnt lgkmcnt(0)
    v_mfma_f32_16x16x32_bf16 v[156:159], a[180:183], a[108:111], v[156:159]
    s_barrier
    ds_read_b128 a[56:59], v194 offset:0
    ds_read_b128 a[60:63], v194 offset:512
    v_mfma_f32_16x16x32_bf16 v[132:135], a[180:183], a[104:107], v[132:135]
    s_addk_i32 m0, 4096
    ds_read_b128 a[64:67], v194 offset:1024
    ds_read_b128 a[68:71], v194 offset:1536
    v_mfma_f32_16x16x32_bf16 v[136:139], a[168:171], a[100:103], v[136:139]
    s_addk_i32 s93, 28672
    ds_read_b128 a[72:75], v194 offset:2048
    ds_read_b128 a[76:79], v194 offset:2560
    v_mfma_f32_16x16x32_bf16 v[112:115], a[168:171], a[96:99], v[112:115]
    ds_read_b128 a[80:83], v194 offset:3072
    ds_read_b128 a[84:87], v194 offset:3584
    v_mfma_f32_16x16x32_bf16 v[140:143], a[172:175], a[100:103], v[140:143]
    ds_read_b128 a[88:91], v194 offset:4096
    ds_read_b128 a[92:95], v194 offset:4608
    v_mfma_f32_16x16x32_bf16 v[116:119], a[172:175], a[96:99], v[116:119]
    buffer_load_dwordx4 v246, s[32:35], s93 offen lds
    s_lshr_b32 s91, s56, 1
    v_mfma_f32_16x16x32_bf16 v[136:139], a[192:195], a[108:111], v[136:139]
    s_lshl_b32 s91, s91, 10
    s_add_u32 s91, s91, s81
    s_add_u32 s91, s91, 8192
    v_mfma_f32_16x16x32_bf16 v[112:115], a[192:195], a[104:107], v[112:115]
    buffer_load_dword v245, v1, s[48:51], s91 offen
    v_cvt_pk_bf16_f32 v200, v144, v145
    v_mfma_f32_16x16x32_bf16 v[140:143], a[196:199], a[108:111], v[140:143]
    v_cvt_pk_bf16_f32 v201, v146, v147
    v_fma_f32 v148, v76, v180, v148
    v_mfma_f32_16x16x32_bf16 v[116:119], a[196:199], a[104:107], v[116:119]
    s_waitcnt lgkmcnt(9)
    ds_read_b128 a[96:99], v194 offset:5120
    ds_read_b128 a[100:103], v194 offset:5632
    v_mfma_f32_16x16x32_bf16 v[160:163], a[0:3], a[56:59], 0
    s_waitcnt lgkmcnt(10)
    ds_read_b128 a[192:195], v194 offset:6144
    ds_read_b128 a[196:199], v194 offset:6656
    v_mfma_f32_16x16x32_bf16 v[160:163], a[4:7], a[60:63], v[160:163]
    s_waitcnt lgkmcnt(11)
    v_fma_f32 v149, v77, v180, v149
    v_fma_f32 v150, v78, v180, v150
    v_mfma_f32_16x16x32_bf16 v[160:163], a[8:11], a[64:67], v[160:163]
    s_waitcnt lgkmcnt(10)
    v_fma_f32 v151, v79, v180, v151
    v_mul_f32 v148, v148, v182
    v_mfma_f32_16x16x32_bf16 v[160:163], a[12:15], a[68:71], v[160:163]
    s_waitcnt lgkmcnt(9)
    v_mul_f32 v149, v149, v182
    v_mul_f32 v150, v150, v182
    v_mfma_f32_16x16x32_bf16 v[160:163], a[16:19], a[72:75], v[160:163]
    s_waitcnt lgkmcnt(8)
    v_mul_f32 v151, v151, v182
    v_cvt_pk_bf16_f32 v202, v148, v149
    v_mfma_f32_16x16x32_bf16 v[160:163], a[20:23], a[76:79], v[160:163]
    s_waitcnt lgkmcnt(7)
    v_cvt_pk_bf16_f32 v203, v150, v151
    ds_write_b128 v253, v[200:203] offset:1024
    v_mfma_f32_16x16x32_bf16 v[160:163], a[24:27], a[80:83], v[160:163]
    s_waitcnt lgkmcnt(7)
    v_fma_f32 v152, v80, v180, v152
    v_fma_f32 v153, v81, v180, v153
    v_mfma_f32_16x16x32_bf16 v[160:163], a[28:31], a[84:87], v[160:163]
    s_waitcnt lgkmcnt(6)
    v_fma_f32 v154, v82, v180, v154
    v_fma_f32 v155, v83, v180, v155
    v_mfma_f32_16x16x32_bf16 v[160:163], a[32:35], a[88:91], v[160:163]
    s_waitcnt lgkmcnt(5)
    v_mul_f32 v152, v152, v181
    v_mul_f32 v153, v153, v181
    v_mfma_f32_16x16x32_bf16 v[160:163], a[36:39], a[92:95], v[160:163]
    s_waitcnt lgkmcnt(4)
    v_mul_f32 v154, v154, v181
    v_mul_f32 v155, v155, v181
    v_mfma_f32_16x16x32_bf16 v[160:163], a[40:43], a[96:99], v[160:163]
    s_waitcnt lgkmcnt(3)
    v_cvt_pk_bf16_f32 v216, v152, v153
    v_cvt_pk_bf16_f32 v217, v154, v155
    v_mfma_f32_16x16x32_bf16 v[160:163], a[44:47], a[100:103], v[160:163]
    s_waitcnt lgkmcnt(2)
    v_fma_f32 v156, v84, v180, v156
    v_fma_f32 v157, v85, v180, v157
    v_mfma_f32_16x16x32_bf16 v[160:163], a[48:51], a[192:195], v[160:163]
    s_waitcnt lgkmcnt(1)
    v_fma_f32 v158, v86, v180, v158
    v_fma_f32 v159, v87, v180, v159
    v_mfma_f32_16x16x32_bf16 v[160:163], a[52:55], a[196:199], v[160:163]
    v_mul_f32 v156, v156, v181
    v_mul_f32 v157, v157, v181
    v_mul_f32 v158, v158, v181
    v_mul_f32 v159, v159, v181
    v_cvt_pk_bf16_f32 v218, v156, v157
    v_cvt_pk_bf16_f32 v219, v158, v159
    ds_write_b128 v17, v[216:219] offset:2048
    v_mov_b32 v173, v172
    s_nop 1
    v_permlane16_swap_b32 v172, v173
    v_add_f32 v172, v172, v173
    v_mov_b32 v173, v172
    s_nop 1
    v_permlane32_swap_b32 v172, v173
    v_mul_f32 v184, 0xbb124925, v172
    v_mul_f32 v192, 0x3b124925, v173
    v_fma_f32 v192, -v184, v184, v192
    v_max_f32 v192, 0, v192
    v_add_f32 v192, 0x3727c5ac, v192
    v_rsq_f32 v185, v192
    s_nop 0
    v_and_b32 v186, v185, v31
    v_pk_fma_f32 v[128:129], v[80:81], v[176:177], v[128:129] op_sel_hi:[1,0,1]
    v_pk_fma_f32 v[130:131], v[82:83], v[176:177], v[130:131] op_sel_hi:[1,0,1]
    v_pk_mul_f32 v[128:129], v[128:129], v[176:177] op_sel:[0,1]
    v_pk_mul_f32 v[130:131], v[130:131], v[176:177] op_sel:[0,1]
    v_pk_fma_f32 v[132:133], v[84:85], v[176:177], v[132:133] op_sel_hi:[1,0,1]
    v_pk_fma_f32 v[134:135], v[86:87], v[176:177], v[134:135] op_sel_hi:[1,0,1]
    v_pk_mul_f32 v[132:133], v[132:133], v[176:177] op_sel:[0,1]
    v_pk_mul_f32 v[134:135], v[134:135], v[176:177] op_sel:[0,1]
    v_cvt_pk_bf16_f32 v212, v128, v129
    v_cvt_pk_bf16_f32 v213, v130, v131
    v_cvt_pk_bf16_f32 v214, v132, v133
    v_cvt_pk_bf16_f32 v215, v134, v135
    ds_write_b128 v17, v[212:215] offset:1024
    v_pk_fma_f32 v[160:161], v[32:33], v[184:185], v[160:161] op_sel_hi:[1,0,1]
    v_pk_fma_f32 v[162:163], v[34:35], v[184:185], v[162:163] op_sel_hi:[1,0,1]
    v_pk_mul_f32 v[160:161], v[160:161], v[186:187] op_sel_hi:[1,0]
    v_pk_mul_f32 v[162:163], v[162:163], v[186:187] op_sel_hi:[1,0]
    v_cvt_pk_bf16_f32 v220, v160, v161
    v_cvt_pk_bf16_f32 v221, v162, v163
    ds_write_b64 v19, v[220:221]
    v_pk_fma_f32 v[112:113], v[64:65], v[176:177], v[112:113] op_sel_hi:[1,0,1]
    v_pk_fma_f32 v[114:115], v[66:67], v[176:177], v[114:115] op_sel_hi:[1,0,1]
    v_pk_fma_f32 v[116:117], v[68:69], v[176:177], v[116:117] op_sel_hi:[1,0,1]
    v_pk_fma_f32 v[118:119], v[70:71], v[176:177], v[118:119] op_sel_hi:[1,0,1]
    v_cvt_pk_bf16_f32 v204, v112, v113
    v_cvt_pk_bf16_f32 v205, v114, v115
    v_cvt_pk_bf16_f32 v206, v116, v117
    v_cvt_pk_bf16_f32 v207, v118, v119
    s_waitcnt lgkmcnt(0)
    s_barrier
    ds_read_b128 v[222:225], v253
    ds_read_b64_tr_b16 v[226:227], v18 offset:0
    ds_read_b64_tr_b16 v[228:229], v18 offset:1024
    ds_read_b64_tr_b16 v[230:231], v18 offset:2048
    ds_read_b64_tr_b16 v[232:233], v18 offset:8
    ds_read_b64_tr_b16 v[234:235], v18 offset:1032
    ds_read_b64_tr_b16 v[236:237], v18 offset:2056
    v_pk_fma_f32 v[120:121], v[72:73], v[176:177], v[120:121] op_sel_hi:[1,0,1]
    v_pk_fma_f32 v[122:123], v[74:75], v[176:177], v[122:123] op_sel_hi:[1,0,1]
    v_pk_mul_f32 v[120:121], v[120:121], v[176:177] op_sel:[0,1]
    v_pk_mul_f32 v[122:123], v[122:123], v[176:177] op_sel:[0,1]
    v_pk_fma_f32 v[124:125], v[76:77], v[176:177], v[124:125] op_sel_hi:[1,0,1]
    v_pk_fma_f32 v[126:127], v[78:79], v[176:177], v[126:127] op_sel_hi:[1,0,1]
    v_pk_mul_f32 v[124:125], v[124:125], v[178:179] op_sel_hi:[1,0]
    v_pk_mul_f32 v[126:127], v[126:127], v[178:179] op_sel_hi:[1,0]
    v_cvt_pk_bf16_f32 v196, v120, v121
    v_cvt_pk_bf16_f32 v197, v122, v123
    v_cvt_pk_bf16_f32 v198, v124, v125
    v_cvt_pk_bf16_f32 v199, v126, v127
    v_pk_fma_f32 v[136:137], v[64:65], v[180:181], v[136:137] op_sel_hi:[1,0,1]
    v_pk_fma_f32 v[138:139], v[66:67], v[180:181], v[138:139] op_sel_hi:[1,0,1]
    v_pk_fma_f32 v[140:141], v[68:69], v[180:181], v[140:141] op_sel_hi:[1,0,1]
    v_pk_fma_f32 v[142:143], v[70:71], v[180:181], v[142:143] op_sel_hi:[1,0,1]
    v_cvt_pk_bf16_f32 v208, v136, v137
    v_cvt_pk_bf16_f32 v209, v138, v139
    v_cvt_pk_bf16_f32 v210, v140, v141
    v_cvt_pk_bf16_f32 v211, v142, v143
    s_nop 1
    v_mfma_f32_16x16x32_bf16 v[124:127], v[200:203], v[208:211], v[36:39]
    v_mfma_f32_16x16x32_bf16 v[120:123], v[196:199], v[208:211], v[40:43]
    v_mfma_f32_16x16x32_bf16 v[116:119], v[196:199], v[204:207], v[36:39]
    s_waitcnt lgkmcnt(6)
    v_mfma_f32_16x16x32_bf16 v[112:115], v[222:225], v[204:207], v[44:47]
    s_nop 3
    v_max3_f32 v129, v124, v125, v126
    v_max3_f32 v129, v129, v127, v120
    v_max3_f32 v129, v129, v121, v122
    v_max_f32 v129, v129, v123
    v_max3_f32 v128, v116, v117, v118
    v_max3_f32 v128, v128, v119, v112
    v_max3_f32 v128, v128, v113, v114
    v_max_f32 v128, v128, v115
    s_nop 1
    v_permlane32_swap_b32 v128, v129
    v_max_f32 v128, v128, v129
    v_mov_b32 v129, v128
    s_nop 1
    v_permlane16_swap_b32 v128, v129
    v_max_f32 v128, v128, v129
    v_mov_b32 v129, v128
    s_nop 1
    v_permlane32_swap_b32 v128, v129
    v_mul_f32 v130, v128, v179
    v_mul_f32 v132, v129, v183
    v_pk_fma_f32 v[112:113], v[112:113], v[178:179], v[130:131] op_sel:[0,1,0] op_sel_hi:[1,1,0] neg_lo:[0,0,1] neg_hi:[0,0,1]
    v_pk_fma_f32 v[114:115], v[114:115], v[178:179], v[130:131] op_sel:[0,1,0] op_sel_hi:[1,1,0] neg_lo:[0,0,1] neg_hi:[0,0,1]
    v_pk_fma_f32 v[116:117], v[116:117], v[178:179], v[130:131] op_sel:[0,1,0] op_sel_hi:[1,1,0] neg_lo:[0,0,1] neg_hi:[0,0,1]
    v_pk_fma_f32 v[118:119], v[118:119], v[178:179], v[130:131] op_sel:[0,1,0] op_sel_hi:[1,1,0] neg_lo:[0,0,1] neg_hi:[0,0,1]
    v_pk_fma_f32 v[120:121], v[120:121], v[182:183], v[132:133] op_sel:[0,1,0] op_sel_hi:[1,1,0] neg_lo:[0,0,1] neg_hi:[0,0,1]
    v_pk_fma_f32 v[122:123], v[122:123], v[182:183], v[132:133] op_sel:[0,1,0] op_sel_hi:[1,1,0] neg_lo:[0,0,1] neg_hi:[0,0,1]
    v_pk_fma_f32 v[124:125], v[124:125], v[182:183], v[132:133] op_sel:[0,1,0] op_sel_hi:[1,1,0] neg_lo:[0,0,1] neg_hi:[0,0,1]
    v_pk_fma_f32 v[126:127], v[126:127], v[182:183], v[132:133] op_sel:[0,1,0] op_sel_hi:[1,1,0] neg_lo:[0,0,1] neg_hi:[0,0,1]
    v_exp_f32 v112, v112
    v_exp_f32 v113, v113
    v_exp_f32 v114, v114
    v_exp_f32 v115, v115
    v_exp_f32 v116, v116
    v_exp_f32 v117, v117
    v_exp_f32 v118, v118
    v_exp_f32 v119, v119
    v_exp_f32 v120, v120
    v_exp_f32 v121, v121
    v_cvt_pk_bf16_f32 v136, v112, v113
    v_cvt_pk_bf16_f32 v137, v114, v115
    v_cvt_pk_bf16_f32 v138, v116, v117
    v_cvt_pk_bf16_f32 v139, v118, v119
    v_exp_f32 v122, v122
    v_exp_f32 v123, v123
    v_mfma_f32_16x16x32_bf16 v[160:163], a[232:235], v[136:139], 0
    v_exp_f32 v124, v124
    s_waitcnt lgkmcnt(4)
    v_mfma_f32_16x16x32_bf16 v[144:147], v[226:229], v[136:139], 0
    v_exp_f32 v125, v125
    s_waitcnt lgkmcnt(1)
    v_mfma_f32_16x16x32_bf16 v[148:151], v[232:235], v[136:139], 0
    v_exp_f32 v126, v126
    v_exp_f32 v127, v127
    v_cvt_pk_bf16_f32 v140, v120, v121
    v_cvt_pk_bf16_f32 v141, v122, v123
    v_cvt_pk_bf16_f32 v142, v124, v125
    v_cvt_pk_bf16_f32 v143, v126, v127
    s_nop 1
    v_mfma_f32_16x16x32_bf16 v[164:167], a[232:235], v[140:143], 0
    v_mfma_f32_16x16x32_bf16 v[152:155], v[228:231], v[140:143], 0
    s_waitcnt lgkmcnt(0)
    v_mfma_f32_16x16x32_bf16 v[156:159], v[234:237], v[140:143], 0
    s_add_u32 s89, s70, 16384
    s_lshl_b32 s88, s66, 4
    s_or_b32 s88, s88, s61
    v_rcp_f32 v160, v160
    s_nop 0
    v_rcp_f32 v164, v164
    v_mov_b32 v255, s88
    s_cmp_eq_u32 s63, 0
    v_pk_mul_f32 v[144:145], v[144:145], v[160:161] op_sel_hi:[1,0]
    v_pk_mul_f32 v[146:147], v[146:147], v[160:161] op_sel_hi:[1,0]
    v_pk_mul_f32 v[148:149], v[148:149], v[160:161] op_sel_hi:[1,0]
    v_pk_mul_f32 v[150:151], v[150:151], v[160:161] op_sel_hi:[1,0]
    v_cvt_pk_bf16_f32 v168, v144, v145
    v_cvt_pk_bf16_f32 v169, v146, v147
    v_cvt_pk_bf16_f32 v170, v148, v149
    v_cvt_pk_bf16_f32 v171, v150, v151
    s_cbranch_scc1 L_ofar_48
    buffer_store_dwordx2 v[168:169], v4, s[48:51], s70 offen
    buffer_store_dwordx2 v[170:171], v5, s[48:51], s70 offen
    v_pk_mul_f32 v[152:153], v[152:153], v[164:165] op_sel_hi:[1,0]
    v_pk_mul_f32 v[154:155], v[154:155], v[164:165] op_sel_hi:[1,0]
    v_pk_mul_f32 v[156:157], v[156:157], v[164:165] op_sel_hi:[1,0]
    v_pk_mul_f32 v[158:159], v[158:159], v[164:165] op_sel_hi:[1,0]
    v_cvt_pk_bf16_f32 v172, v152, v153
    v_cvt_pk_bf16_f32 v173, v154, v155
    v_cvt_pk_bf16_f32 v174, v156, v157
    v_cvt_pk_bf16_f32 v175, v158, v159
    buffer_store_dwordx2 v[172:173], v4, s[48:51], s89 offen
    buffer_store_dwordx2 v[174:175], v5, s[48:51], s89 offen
L_ostored_49:
    ds_write_b128 v244, a[140:143] offset:57344
    ds_write_b128 v244, a[144:147] offset:58368
    ds_write_b128 v244, a[148:151] offset:59392
    ds_write_b128 v244, a[152:155] offset:60416
    ds_write_b128 v244, a[156:159] offset:61440
    ds_write_b128 v244, a[160:163] offset:62464
    ds_write_b128 v244, a[164:167] offset:63488
    s_waitcnt vmcnt(0)
    s_cmp_eq_u32 s63, 0
    s_cbranch_scc1 L_pubslow_50
    s_mov_b64 exec, 1
    buffer_store_dword v255, off, s[48:51], s75
L_pubdone_51:
    s_mov_b64 exec, -1
    s_mov_b32 s65, 1
    s_mov_b64 s[24:25], s[32:33]
    s_mov_b32 s26, 401408
    s_branch L_p
L_qb:
    v_mad_u32_u24 v112, v30, s66, v29
    buffer_load_dword v114, v14, s[48:51], 0 offen sc1
    s_cmp_lg_u32 s64, 0
    s_cbranch_scc1 L_ab2_59
    s_add_u32 m0, s5, 0
    s_add_u32 s94, s4, 0
    buffer_load_dwordx4 v1, s[48:51], s94 offen lds
    s_add_u32 m0, s5, 1024
    s_add_u32 s94, s4, 1024
    buffer_load_dwordx4 v1, s[48:51], s94 offen lds
    s_add_u32 m0, s5, 2048
    s_add_u32 s94, s4, 2048
    buffer_load_dwordx4 v1, s[48:51], s94 offen lds
    s_add_u32 m0, s5, 3072
    s_add_u32 s94, s4, 3072
    buffer_load_dwordx4 v1, s[48:51], s94 offen lds
    s_add_u32 m0, s5, 4096
    s_add_u32 s94, s4, 4096
    buffer_load_dwordx4 v1, s[48:51], s94 offen lds
    s_add_u32 m0, s5, 5120
    s_add_u32 s94, s4, 5120
    buffer_load_dwordx4 v1, s[48:51], s94 offen lds
    s_add_u32 m0, s5, 6144
    s_add_u32 s94, s4, 6144
    buffer_load_dwordx4 v1, s[48:51], s94 offen lds
    s_waitcnt vmcnt(8)
    s_barrier
    s_lshl_b32 s88, s58, 6
    ds_read_b128 a[168:171], v6 offset:0
    ds_read_b128 a[172:175], v6 offset:2048
    ds_read_b128 a[176:179], v6 offset:4096
    ds_read_b128 a[180:183], v6 offset:6144
    s_waitcnt lgkmcnt(3)
    v_mfma_f32_16x16x32_bf16 v[192:195], a[168:171], a[232:235], 0
    s_waitcnt lgkmcnt(2)
    ds_read_b128 a[168:171], v6 offset:8192
    v_mfma_f32_16x16x32_bf16 v[192:195], a[172:175], a[232:235], v[192:195]
    s_waitcnt lgkmcnt(2)
    ds_read_b128 a[172:175], v6 offset:10240
    v_mfma_f32_16x16x32_bf16 v[192:195], a[176:179], a[232:235], v[192:195]
    s_waitcnt lgkmcnt(2)
    ds_read_b128 a[176:179], v6 offset:12288
    v_mfma_f32_16x16x32_bf16 v[192:195], a[180:183], a[232:235], v[192:195]
    s_waitcnt lgkmcnt(2)
    ds_read_b128 a[180:183], v6 offset:14336
    v_mfma_f32_16x16x32_bf16 v[192:195], a[168:171], a[232:235], v[192:195]
    s_waitcnt lgkmcnt(2)
    ds_read_b128 a[168:171], v6 offset:16384
    v_mfma_f32_16x16x32_bf16 v[192:195], a[172:175], a[232:235], v[192:195]
    s_waitcnt lgkmcnt(2)
    ds_read_b128 a[172:175], v6 offset:18432
    v_mfma_f32_16x16x32_bf16 v[192:195], a[176:179], a[232:235], v[192:195]
    s_waitcnt lgkmcnt(2)
    ds_read_b128 a[176:179], v6 offset:20480
    v_mfma_f32_16x16x32_bf16 v[192:195], a[180:183], a[232:235], v[192:195]
    s_waitcnt lgkmcnt(2)
    ds_read_b128 a[180:183], v6 offset:22528
    v_mfma_f32_16x16x32_bf16 v[192:195], a[168:171], a[232:235], v[192:195]
    s_waitcnt lgkmcnt(2)
    ds_read_b128 a[168:171], v6 offset:24576
    v_mfma_f32_16x16x32_bf16 v[192:195], a[172:175], a[232:235], v[192:195]
    s_waitcnt lgkmcnt(2)
    ds_read_b128 a[172:175], v6 offset:26624
    v_mfma_f32_16x16x32_bf16 v[192:195], a[176:179], a[232:235], v[192:195]
    s_waitcnt lgkmcnt(2)
    v_mfma_f32_16x16x32_bf16 v[192:195], a[180:183], a[232:235], v[192:195]
    s_waitcnt lgkmcnt(1)
    v_mfma_f32_16x16x32_bf16 v[192:195], a[168:171], a[232:235], v[192:195]
    s_waitcnt lgkmcnt(0)
    v_mfma_f32_16x16x32_bf16 v[192:195], a[172:175], a[232:235], v[192:195]
    v_lshrrev_b32 v189, 8, v1
    v_lshlrev_b32 v189, 4, v189
    s_add_u32 s88, s88, 161920
    v_add_u32 v189, s88, v189
    s_mov_b32 s96, 0x00010001
    s_mov_b32 s97, 0x00010001
    s_nop 1
    s_mov_b64 exec, s[96:97]
    ds_write_b128 v189, v[192:195]
    s_mov_b64 exec, -1
    s_waitcnt lgkmcnt(0)
    s_branch L_abdone_60
L_ab2_59:
    ds_write_b128 v244, a[112:115] offset:28672
    ds_write_b128 v244, a[116:119] offset:29696
    ds_write_b128 v244, a[120:123] offset:30720
    ds_write_b128 v244, a[124:127] offset:31744
    ds_write_b128 v244, a[128:131] offset:32768
    ds_write_b128 v244, a[132:135] offset:33792
    ds_write_b128 v244, a[136:139] offset:34816
L_abdone_60:
    s_branch L_qchk_58
L_qpoll_52:
    s_waitcnt vmcnt(0)
    buffer_load_dword v114, v14, s[48:51], 0 offen sc1
L_qchk_58:
    s_cmp_eq_u32 s84, 0
    s_waitcnt vmcnt(0)
    s_cbranch_scc0 L_pend_54
L_nopend_55:
    v_xor_b32 v113, v114, v112
    v_cmp_ne_u32 vcc, 0, v113
    s_cbranch_vccnz L_qslow_56
L_qpass_53:
    s_add_u32 s89, s68, 0
    s_add_u32 s90, s68, 14336
    buffer_load_dwordx4 a[0:3], v1, s[48:51], s89 offen offset:0 sc1
    buffer_load_dwordx4 a[4:7], v1, s[48:51], s90 offen offset:0 sc1
    buffer_load_dwordx4 a[8:11], v1, s[48:51], s89 offen offset:1024 sc1
    buffer_load_dwordx4 a[12:15], v1, s[48:51], s90 offen offset:1024 sc1
    s_waitcnt lgkmcnt(0)
    s_barrier
    s_cmp_lg_u32 s64, 0
    s_cbranch_scc1 L_once_61
    v_lshrrev_b32 v188, 8, v1
    v_lshlrev_b32 v188, 4, v188
    v_add_u32 v188, 161792, v188
    ds_read_b128 v[96:99], v188 offset:128
    ds_read_b128 v[100:103], v188 offset:192
    ds_read_b128 v[104:107], v188 offset:256
    ds_read_b128 v[108:111], v188 offset:320
    s_waitcnt lgkmcnt(0)
L_once_61:
    ds_read_b128 a[176:179], v1 offset:28672
    ds_read_b128 a[180:183], v1 offset:29696
    ds_read_b128 a[184:187], v240 offset:0
    ds_read_b128 a[188:191], v240 offset:1024
    buffer_load_dwordx4 a[16:19], v1, s[48:51], s89 offen offset:2048 sc1
    buffer_load_dwordx4 a[20:23], v1, s[48:51], s90 offen offset:2048 sc1
    s_waitcnt vmcnt(5) lgkmcnt(3)
    v_mfma_f32_16x16x32_bf16 v[120:123], a[176:179], a[0:3], 0
    s_waitcnt vmcnt(4)
    buffer_load_dwordx4 a[24:27], v1, s[48:51], s89 offen offset:3072 sc1
    v_mfma_f32_16x16x32_bf16 v[144:147], a[176:179], a[4:7], 0
    s_waitcnt lgkmcnt(2)
    ds_read_b128 a[176:179], v1 offset:30720
    v_mfma_f32_16x16x32_bf16 v[124:127], a[180:183], a[0:3], 0
    v_mfma_f32_16x16x32_bf16 v[148:151], a[180:183], a[4:7], 0
    s_waitcnt lgkmcnt(2)
    ds_read_b128 a[180:183], v1 offset:31744
    v_mfma_f32_16x16x32_bf16 v[128:131], a[184:187], a[0:3], 0
    buffer_load_dwordx4 a[28:31], v1, s[48:51], s90 offen offset:3072 sc1
    s_add_u32 s89, s68, 4096
    v_mfma_f32_16x16x32_bf16 v[152:155], a[184:187], a[4:7], 0
    s_waitcnt lgkmcnt(2)
    ds_read_b128 a[184:187], v240 offset:2048
    s_add_u32 s90, s68, 18432
    v_mfma_f32_16x16x32_bf16 v[132:135], a[188:191], a[0:3], 0
    buffer_load_dwordx4 a[32:35], v1, s[48:51], s89 offen offset:0 sc1
    buffer_load_dwordx4 a[36:39], v1, s[48:51], s90 offen offset:0 sc1
    v_mfma_f32_16x16x32_bf16 v[156:159], a[188:191], a[4:7], 0
    s_waitcnt vmcnt(7) lgkmcnt(2)
    ds_read_b128 a[188:191], v240 offset:3072
    v_mfma_f32_16x16x32_bf16 v[120:123], a[176:179], a[8:11], v[120:123]
    s_waitcnt vmcnt(6)
    buffer_load_dwordx4 a[40:43], v1, s[48:51], s89 offen offset:1024 sc1
    v_mfma_f32_16x16x32_bf16 v[144:147], a[176:179], a[12:15], v[144:147]
    s_waitcnt lgkmcnt(2)
    ds_read_b128 a[176:179], v1 offset:32768
    v_mfma_f32_16x16x32_bf16 v[124:127], a[180:183], a[8:11], v[124:127]
    v_mfma_f32_16x16x32_bf16 v[148:151], a[180:183], a[12:15], v[148:151]
    s_waitcnt lgkmcnt(2)
    ds_read_b128 a[180:183], v1 offset:33792
    v_mfma_f32_16x16x32_bf16 v[128:131], a[184:187], a[8:11], v[128:131]
    buffer_load_dwordx4 a[44:47], v1, s[48:51], s90 offen offset:1024 sc1
    v_mfma_f32_16x16x32_bf16 v[152:155], a[184:187], a[12:15], v[152:155]
    s_waitcnt lgkmcnt(2)
    ds_read_b128 a[184:187], v240 offset:4096
    v_mfma_f32_16x16x32_bf16 v[132:135], a[188:191], a[8:11], v[132:135]
    v_mfma_f32_16x16x32_bf16 v[156:159], a[188:191], a[12:15], v[156:159]
    s_waitcnt vmcnt(7) lgkmcnt(2)
    ds_read_b128 a[188:191], v240 offset:5120
    v_mfma_f32_16x16x32_bf16 v[120:123], a[176:179], a[16:19], v[120:123]
    s_waitcnt vmcnt(6)
    buffer_load_dwordx4 a[48:51], v1, s[48:51], s89 offen offset:2048 sc1
    v_mfma_f32_16x16x32_bf16 v[144:147], a[176:179], a[20:23], v[144:147]
    s_waitcnt lgkmcnt(2)
    ds_read_b128 a[176:179], v1 offset:34816
    v_mfma_f32_16x16x32_bf16 v[124:127], a[180:183], a[16:19], v[124:127]
    v_mfma_f32_16x16x32_bf16 v[148:151], a[180:183], a[20:23], v[148:151]
    s_waitcnt lgkmcnt(2)
    ds_read_b128 a[180:183], v1 offset:35840
    v_mfma_f32_16x16x32_bf16 v[128:131], a[184:187], a[16:19], v[128:131]
    buffer_load_dwordx4 a[52:55], v1, s[48:51], s90 offen offset:2048 sc1
    v_mfma_f32_16x16x32_bf16 v[152:155], a[184:187], a[20:23], v[152:155]
    s_waitcnt lgkmcnt(2)
    ds_read_b128 a[184:187], v240 offset:6144
    v_mfma_f32_16x16x32_bf16 v[132:135], a[188:191], a[16:19], v[132:135]
    v_mfma_f32_16x16x32_bf16 v[156:159], a[188:191], a[20:23], v[156:159]
    s_waitcnt vmcnt(7) lgkmcnt(2)
    ds_read_b128 a[188:191], v240 offset:7168
    v_mfma_f32_16x16x32_bf16 v[120:123], a[176:179], a[24:27], v[120:123]
    s_waitcnt vmcnt(6)
    buffer_load_dwordx4 a[56:59], v1, s[48:51], s89 offen offset:3072 sc1
    v_mfma_f32_16x16x32_bf16 v[144:147], a[176:179], a[28:31], v[144:147]
    s_waitcnt lgkmcnt(2)
    ds_read_b128 a[176:179], v1 offset:36864
    v_mfma_f32_16x16x32_bf16 v[124:127], a[180:183], a[24:27], v[124:127]
    v_mfma_f32_16x16x32_bf16 v[148:151], a[180:183], a[28:31], v[148:151]
    s_waitcnt lgkmcnt(2)
    ds_read_b128 a[180:183], v1 offset:37888
    v_mfma_f32_16x16x32_bf16 v[128:131], a[184:187], a[24:27], v[128:131]
    buffer_load_dwordx4 a[60:63], v1, s[48:51], s90 offen offset:3072 sc1
    v_mfma_f32_16x16x32_bf16 v[152:155], a[184:187], a[28:31], v[152:155]
    s_waitcnt lgkmcnt(2)
    ds_read_b128 a[184:187], v240 offset:8192
    v_mfma_f32_16x16x32_bf16 v[132:135], a[188:191], a[24:27], v[132:135]
    v_mfma_f32_16x16x32_bf16 v[156:159], a[188:191], a[28:31], v[156:159]
    s_waitcnt vmcnt(7) lgkmcnt(2)
    ds_read_b128 a[188:191], v240 offset:9216
    buffer_load_dwordx2 v[164:165], v21, s[48:51], s69 offen offset:0 sc1
    v_mfma_f32_16x16x32_bf16 v[120:123], a[176:179], a[32:35], v[120:123]
    s_waitcnt vmcnt(7)
    v_mfma_f32_16x16x32_bf16 v[144:147], a[176:179], a[36:39], v[144:147]
    s_waitcnt lgkmcnt(2)
    ds_read_b128 a[176:179], v1 offset:38912
    buffer_load_dwordx2 v[166:167], v21, s[48:51], s69 offen offset:512 sc1
    v_mfma_f32_16x16x32_bf16 v[124:127], a[180:183], a[32:35], v[124:127]
    s_add_u32 s89, s68, 8192
    s_add_u32 s90, s68, 22528
    buffer_load_dwordx4 a[64:67], v1, s[48:51], s89 offen offset:0 sc1
    v_mfma_f32_16x16x32_bf16 v[148:151], a[180:183], a[36:39], v[148:151]
    s_waitcnt lgkmcnt(2)
    ds_read_b128 a[180:183], v1 offset:39936
    v_mfma_f32_16x16x32_bf16 v[128:131], a[184:187], a[32:35], v[128:131]
    buffer_load_dwordx4 a[68:71], v1, s[48:51], s90 offen offset:0 sc1
    v_mfma_f32_16x16x32_bf16 v[152:155], a[184:187], a[36:39], v[152:155]
    s_waitcnt lgkmcnt(2)
    ds_read_b128 a[184:187], v240 offset:10240
    v_mfma_f32_16x16x32_bf16 v[132:135], a[188:191], a[32:35], v[132:135]
    v_mfma_f32_16x16x32_bf16 v[156:159], a[188:191], a[36:39], v[156:159]
    s_waitcnt vmcnt(9) lgkmcnt(2)
    ds_read_b128 a[188:191], v240 offset:11264
    buffer_load_dwordx2 v[168:169], v21, s[48:51], s69 offen offset:1024 sc1
    v_mfma_f32_16x16x32_bf16 v[120:123], a[176:179], a[40:43], v[120:123]
    s_waitcnt vmcnt(9)
    v_mfma_f32_16x16x32_bf16 v[144:147], a[176:179], a[44:47], v[144:147]
    s_waitcnt lgkmcnt(2)
    ds_read_b128 a[176:179], v1 offset:40960
    buffer_load_dwordx2 v[170:171], v21, s[48:51], s69 offen offset:1536 sc1
    v_mfma_f32_16x16x32_bf16 v[124:127], a[180:183], a[40:43], v[124:127]
    buffer_load_dwordx4 a[72:75], v1, s[48:51], s89 offen offset:1024 sc1
    v_mfma_f32_16x16x32_bf16 v[148:151], a[180:183], a[44:47], v[148:151]
    s_waitcnt lgkmcnt(2)
    ds_read_b128 a[180:183], v1 offset:41984
    v_mfma_f32_16x16x32_bf16 v[128:131], a[184:187], a[40:43], v[128:131]
    buffer_load_dwordx4 a[76:79], v1, s[48:51], s90 offen offset:1024 sc1
    v_mfma_f32_16x16x32_bf16 v[152:155], a[184:187], a[44:47], v[152:155]
    s_waitcnt lgkmcnt(2)
    ds_read_b128 a[184:187], v240 offset:12288
    v_mfma_f32_16x16x32_bf16 v[132:135], a[188:191], a[40:43], v[132:135]
    v_mfma_f32_16x16x32_bf16 v[156:159], a[188:191], a[44:47], v[156:159]
    s_waitcnt vmcnt(11) lgkmcnt(2)
    ds_read_b128 a[188:191], v240 offset:13312
    v_mfma_f32_16x16x32_bf16 v[120:123], a[176:179], a[48:51], v[120:123]
    s_waitcnt vmcnt(10)
    buffer_load_dwordx4 a[80:83], v1, s[48:51], s89 offen offset:2048 sc1
    s_waitcnt vmcnt(7)
    v_and_b32 v166, v166, v20
    v_mfma_f32_16x16x32_bf16 v[144:147], a[176:179], a[52:55], v[144:147]
    s_waitcnt lgkmcnt(2)
    ds_read_b128 a[176:179], v1 offset:43008
    s_waitcnt vmcnt(3)
    v_and_b32 v170, v170, v20
    v_mfma_f32_16x16x32_bf16 v[124:127], a[180:183], a[48:51], v[124:127]
    v_and_b32 v167, v167, v20
    v_and_b32 v171, v171, v20
    v_mfma_f32_16x16x32_bf16 v[148:151], a[180:183], a[52:55], v[148:151]
    s_waitcnt lgkmcnt(2)
    ds_read_b128 a[180:183], v1 offset:44032
    v_add_f32 v164, v164, v166
    v_mfma_f32_16x16x32_bf16 v[128:131], a[184:187], a[48:51], v[128:131]
    buffer_load_dwordx4 a[84:87], v1, s[48:51], s90 offen offset:2048 sc1
    v_add_f32 v168, v168, v170
    v_mfma_f32_16x16x32_bf16 v[152:155], a[184:187], a[52:55], v[152:155]
    s_waitcnt lgkmcnt(2)
    ds_read_b128 a[184:187], v240 offset:14336
    v_add_f32 v165, v165, v167
    v_mfma_f32_16x16x32_bf16 v[132:135], a[188:191], a[48:51], v[132:135]
    v_add_f32 v169, v169, v171
    v_mfma_f32_16x16x32_bf16 v[156:159], a[188:191], a[52:55], v[156:159]
    s_waitcnt lgkmcnt(2)
    ds_read_b128 a[188:191], v240 offset:15360
    v_mfma_f32_16x16x32_bf16 v[120:123], a[176:179], a[56:59], v[120:123]
    buffer_load_dwordx4 a[88:91], v1, s[48:51], s89 offen offset:3072 sc1
    v_mfma_f32_16x16x32_bf16 v[144:147], a[176:179], a[60:63], v[144:147]
    s_waitcnt lgkmcnt(2)
    ds_read_b128 a[176:179], v1 offset:45056
    v_mfma_f32_16x16x32_bf16 v[124:127], a[180:183], a[56:59], v[124:127]
    v_permlane32_swap_b32 v164, v165
    v_mfma_f32_16x16x32_bf16 v[148:151], a[180:183], a[60:63], v[148:151]
    s_waitcnt lgkmcnt(2)
    ds_read_b128 a[180:183], v1 offset:46080
    v_mfma_f32_16x16x32_bf16 v[128:131], a[184:187], a[56:59], v[128:131]
    buffer_load_dwordx4 a[92:95], v1, s[48:51], s90 offen offset:3072 sc1
    v_mfma_f32_16x16x32_bf16 v[152:155], a[184:187], a[60:63], v[152:155]
    s_waitcnt lgkmcnt(2)
    ds_read_b128 a[184:187], v240 offset:16384
    v_mfma_f32_16x16x32_bf16 v[132:135], a[188:191], a[56:59], v[132:135]
    v_permlane32_swap_b32 v168, v169
    v_mfma_f32_16x16x32_bf16 v[156:159], a[188:191], a[60:63], v[156:159]
    s_waitcnt lgkmcnt(2)
    ds_read_b128 a[188:191], v240 offset:17408
    v_add_f32 v164, v164, v165
    v_mfma_f32_16x16x32_bf16 v[120:123], a[176:179], a[64:67], v[120:123]
    s_add_u32 s89, s68, 12288
    s_add_u32 s90, s68, 26624
    buffer_load_dwordx4 a[96:99], v1, s[48:51], s89 offen offset:0 sc1
    v_mfma_f32_16x16x32_bf16 v[144:147], a[176:179], a[68:71], v[144:147]
    s_waitcnt lgkmcnt(2)
    ds_read_b128 a[176:179], v1 offset:47104
    v_add_f32 v168, v168, v169
    v_mfma_f32_16x16x32_bf16 v[124:127], a[180:183], a[64:67], v[124:127]
    v_mov_b32 v165, v164
    v_mov_b32 v169, v168
    v_mfma_f32_16x16x32_bf16 v[148:151], a[180:183], a[68:71], v[148:151]
    s_waitcnt lgkmcnt(2)
    ds_read_b128 a[180:183], v1 offset:48128
    v_mfma_f32_16x16x32_bf16 v[128:131], a[184:187], a[64:67], v[128:131]
    buffer_load_dwordx4 a[100:103], v1, s[48:51], s90 offen offset:0 sc1
    v_mfma_f32_16x16x32_bf16 v[152:155], a[184:187], a[68:71], v[152:155]
    s_waitcnt lgkmcnt(2)
    ds_read_b128 a[184:187], v240 offset:18432
    v_mfma_f32_16x16x32_bf16 v[132:135], a[188:191], a[64:67], v[132:135]
    v_permlane16_swap_b32 v164, v165
    v_mfma_f32_16x16x32_bf16 v[156:159], a[188:191], a[68:71], v[156:159]
    s_waitcnt vmcnt(7) lgkmcnt(2)
    ds_read_b128 a[188:191], v240 offset:19456
    v_mfma_f32_16x16x32_bf16 v[120:123], a[176:179], a[72:75], v[120:123]
    s_waitcnt vmcnt(6)
    buffer_load_dwordx4 a[104:107], v1, s[48:51], s89 offen offset:1024 sc1
    v_mfma_f32_16x16x32_bf16 v[144:147], a[176:179], a[76:79], v[144:147]
    s_waitcnt lgkmcnt(2)
    ds_read_b128 a[176:179], v1 offset:49152
    v_mfma_f32_16x16x32_bf16 v[124:127], a[180:183], a[72:75], v[124:127]
    v_permlane16_swap_b32 v168, v169
    v_mfma_f32_16x16x32_bf16 v[148:151], a[180:183], a[76:79], v[148:151]
    s_waitcnt lgkmcnt(2)
    ds_read_b128 a[180:183], v1 offset:50176
    v_add_f32 v164, v164, v165
    v_mfma_f32_16x16x32_bf16 v[128:131], a[184:187], a[72:75], v[128:131]
    buffer_load_dwordx4 a[108:111], v1, s[48:51], s90 offen offset:1024 sc1
    v_add_f32 v168, v168, v169
    v_mfma_f32_16x16x32_bf16 v[152:155], a[184:187], a[76:79], v[152:155]
    s_waitcnt lgkmcnt(2)
    ds_read_b128 a[184:187], v240 offset:20480
    v_mov_b32 v165, v164
    v_mfma_f32_16x16x32_bf16 v[132:135], a[188:191], a[72:75], v[132:135]
    v_mov_b32 v169, v168
    v_mfma_f32_16x16x32_bf16 v[156:159], a[188:191], a[76:79], v[156:159]
    s_waitcnt vmcnt(7) lgkmcnt(2)
    ds_read_b128 a[188:191], v240 offset:21504
    v_mfma_f32_16x16x32_bf16 v[120:123], a[176:179], a[80:83], v[120:123]
    s_waitcnt vmcnt(6)
    v_permlane32_swap_b32 v164, v165
    v_mfma_f32_16x16x32_bf16 v[144:147], a[176:179], a[84:87], v[144:147]
    s_waitcnt lgkmcnt(2)
    ds_read_b128 a[176:179], v1 offset:51200
    v_mfma_f32_16x16x32_bf16 v[124:127], a[180:183], a[80:83], v[124:127]
    v_permlane32_swap_b32 v168, v169
    v_mfma_f32_16x16x32_bf16 v[148:151], a[180:183], a[84:87], v[148:151]
    s_waitcnt lgkmcnt(2)
    ds_read_b128 a[180:183], v1 offset:52224
    v_mul_f32 v176, 0xbb124925, v164
    v_mfma_f32_16x16x32_bf16 v[128:131], a[184:187], a[80:83], v[128:131]
    v_mul_f32 v180, 0xbb124925, v168
    v_mul_f32 v188, 0x3b124925, v165
    v_mfma_f32_16x16x32_bf16 v[152:155], a[184:187], a[84:87], v[152:155]
    s_waitcnt lgkmcnt(2)
    ds_read_b128 a[184:187], v240 offset:22528
    v_mul_f32 v190, 0x3b124925, v169
    v_mfma_f32_16x16x32_bf16 v[132:135], a[188:191], a[80:83], v[132:135]
    v_fma_f32 v188, -v176, v176, v188
    v_fma_f32 v190, -v180, v180, v190
    v_mfma_f32_16x16x32_bf16 v[156:159], a[188:191], a[84:87], v[156:159]
    s_waitcnt vmcnt(5) lgkmcnt(2)
    ds_read_b128 a[188:191], v240 offset:23552
    v_max_f32 v188, 0, v188
    v_mfma_f32_16x16x32_bf16 v[120:123], a[176:179], a[88:91], v[120:123]
    s_waitcnt vmcnt(4)
    v_max_f32 v190, 0, v190
    v_add_f32 v188, 0x3727c5ac, v188
    v_mfma_f32_16x16x32_bf16 v[144:147], a[176:179], a[92:95], v[144:147]
    s_waitcnt lgkmcnt(2)
    ds_read_b128 a[176:179], v1 offset:53248
    v_add_f32 v190, 0x3727c5ac, v190
    v_mfma_f32_16x16x32_bf16 v[124:127], a[180:183], a[88:91], v[124:127]
    v_rsq_f32 v177, v188
    v_mfma_f32_16x16x32_bf16 v[148:151], a[180:183], a[92:95], v[148:151]
    s_waitcnt lgkmcnt(2)
    ds_read_b128 a[180:183], v1 offset:54272
    v_mfma_f32_16x16x32_bf16 v[128:131], a[184:187], a[88:91], v[128:131]
    v_rsq_f32 v181, v190
    v_mfma_f32_16x16x32_bf16 v[152:155], a[184:187], a[92:95], v[152:155]
    s_waitcnt lgkmcnt(2)
    ds_read_b128 a[184:187], v240 offset:24576
    v_and_b32 v178, v177, v20
    v_mfma_f32_16x16x32_bf16 v[132:135], a[188:191], a[88:91], v[132:135]
    v_and_b32 v182, v181, v20
    v_mul_f32 v179, 0x3fb8aa3b, v177
    v_mfma_f32_16x16x32_bf16 v[156:159], a[188:191], a[92:95], v[156:159]
    s_waitcnt vmcnt(3) lgkmcnt(2)
    ds_read_b128 a[188:191], v240 offset:25600
    v_mul_f32 v183, 0x3fb8aa3b, v181
    v_mfma_f32_16x16x32_bf16 v[120:123], a[176:179], a[96:99], v[120:123]
    s_waitcnt vmcnt(2)
    v_mfma_f32_16x16x32_bf16 v[144:147], a[176:179], a[100:103], v[144:147]
    s_waitcnt lgkmcnt(2)
    ds_read_b128 a[176:179], v1 offset:55296
    v_mfma_f32_16x16x32_bf16 v[124:127], a[180:183], a[96:99], v[124:127]
    v_mfma_f32_16x16x32_bf16 v[148:151], a[180:183], a[100:103], v[148:151]
    s_waitcnt lgkmcnt(2)
    ds_read_b128 a[180:183], v1 offset:56320
    v_mfma_f32_16x16x32_bf16 v[128:131], a[184:187], a[96:99], v[128:131]
    v_mfma_f32_16x16x32_bf16 v[152:155], a[184:187], a[100:103], v[152:155]
    s_waitcnt lgkmcnt(2)
    ds_read_b128 a[184:187], v240 offset:26624
    v_mfma_f32_16x16x32_bf16 v[132:135], a[188:191], a[96:99], v[132:135]
    v_mfma_f32_16x16x32_bf16 v[156:159], a[188:191], a[100:103], v[156:159]
    s_waitcnt vmcnt(0) lgkmcnt(2)
    ds_read_b128 a[188:191], v240 offset:27648
    v_mfma_f32_16x16x32_bf16 v[144:147], a[176:179], a[108:111], v[144:147]
    v_mfma_f32_16x16x32_bf16 v[120:123], a[176:179], a[104:107], v[120:123]
    s_waitcnt lgkmcnt(2)
    v_mfma_f32_16x16x32_bf16 v[148:151], a[180:183], a[108:111], v[148:151]
    v_mfma_f32_16x16x32_bf16 v[124:127], a[180:183], a[104:107], v[124:127]
    s_waitcnt lgkmcnt(1)
    v_mfma_f32_16x16x32_bf16 v[152:155], a[184:187], a[108:111], v[152:155]
    s_nop 1
    v_fma_f32 v144, v96, v180, v144
    v_fma_f32 v145, v97, v180, v145
    v_mfma_f32_16x16x32_bf16 v[128:131], a[184:187], a[104:107], v[128:131]
    s_waitcnt lgkmcnt(0)
    v_fma_f32 v146, v98, v180, v146
    v_fma_f32 v147, v99, v180, v147
    v_mfma_f32_16x16x32_bf16 v[156:159], a[188:191], a[108:111], v[156:159]
    v_cvt_pk_bf16_f32 v200, v144, v145
    v_cvt_pk_bf16_f32 v201, v146, v147
    v_mfma_f32_16x16x32_bf16 v[132:135], a[188:191], a[104:107], v[132:135]
    v_fma_f32 v148, v100, v180, v148
    v_fma_f32 v149, v101, v180, v149
    v_fma_f32 v150, v102, v180, v150
    v_fma_f32 v151, v103, v180, v151
    v_cvt_pk_bf16_f32 v202, v148, v149
    v_cvt_pk_bf16_f32 v203, v150, v151
    v_subrev_u32 v220, 5120, v17
    v_pk_fma_f32 v[120:121], v[96:97], v[176:177], v[120:121] op_sel_hi:[1,0,1]
    v_pk_fma_f32 v[122:123], v[98:99], v[176:177], v[122:123] op_sel_hi:[1,0,1]
    v_pk_fma_f32 v[124:125], v[100:101], v[176:177], v[124:125] op_sel_hi:[1,0,1]
    v_pk_fma_f32 v[126:127], v[102:103], v[176:177], v[126:127] op_sel_hi:[1,0,1]
    v_cvt_pk_bf16_f32 v196, v120, v121
    v_cvt_pk_bf16_f32 v197, v122, v123
    v_cvt_pk_bf16_f32 v198, v124, v125
    v_cvt_pk_bf16_f32 v199, v126, v127
    v_pk_fma_f32 v[152:153], v[104:105], v[180:181], v[152:153] op_sel_hi:[1,0,1]
    v_pk_fma_f32 v[154:155], v[106:107], v[180:181], v[154:155] op_sel_hi:[1,0,1]
    v_pk_mul_f32 v[152:153], v[152:153], v[180:181] op_sel:[0,1]
    v_pk_mul_f32 v[154:155], v[154:155], v[180:181] op_sel:[0,1]
    v_pk_fma_f32 v[156:157], v[108:109], v[180:181], v[156:157] op_sel_hi:[1,0,1]
    v_pk_fma_f32 v[158:159], v[110:111], v[180:181], v[158:159] op_sel_hi:[1,0,1]
    v_pk_fma_f32 v[156:157], v[156:157], v[182:183], v[22:23] op_sel_hi:[1,0,1]
    v_pk_mul_f32 v[158:159], v[158:159], v[182:183] op_sel_hi:[1,0]
    v_cvt_pk_bf16_f32 v216, v152, v153
    v_cvt_pk_bf16_f32 v217, v154, v155
    v_cvt_pk_bf16_f32 v218, v156, v157
    v_cvt_pk_bf16_f32 v219, v158, v159
    ds_write_b128 v220, v[216:219] offset:17408
    v_pk_fma_f32 v[128:129], v[104:105], v[176:177], v[128:129] op_sel_hi:[1,0,1]
    v_pk_fma_f32 v[130:131], v[106:107], v[176:177], v[130:131] op_sel_hi:[1,0,1]
    v_pk_mul_f32 v[128:129], v[128:129], v[176:177] op_sel:[0,1]
    v_pk_mul_f32 v[130:131], v[130:131], v[176:177] op_sel:[0,1]
    v_pk_fma_f32 v[132:133], v[108:109], v[176:177], v[132:133] op_sel_hi:[1,0,1]
    v_pk_fma_f32 v[134:135], v[110:111], v[176:177], v[134:135] op_sel_hi:[1,0,1]
    v_pk_fma_f32 v[132:133], v[132:133], v[178:179], v[22:23] op_sel_hi:[1,0,1]
    v_pk_mul_f32 v[134:135], v[134:135], v[178:179] op_sel_hi:[1,0]
    v_cvt_pk_bf16_f32 v212, v128, v129
    v_cvt_pk_bf16_f32 v213, v130, v131
    v_cvt_pk_bf16_f32 v214, v132, v133
    v_cvt_pk_bf16_f32 v215, v134, v135
    ds_write_b128 v220, v[212:215] offset:16384
    v_mfma_f32_16x16x32_bf16 v[120:123], a[242:245], v[196:199], 0
    v_mfma_f32_16x16x32_bf16 v[124:127], a[246:249], v[196:199], 0
    v_mfma_f32_16x16x32_bf16 v[128:131], a[242:245], v[200:203], 0
    v_mfma_f32_16x16x32_bf16 v[132:135], a[246:249], v[200:203], 0
    v_mov_b32 v204, v179
    v_sub_f32 v205, 0, v179
    v_mov_b32 v206, v183
    v_sub_f32 v207, 0, v183
    s_nop 0
    v_max3_f32 v188, v120, v121, v122
    v_min3_f32 v190, v120, v121, v122
    v_max3_f32 v188, v188, v123, v124
    v_min3_f32 v190, v190, v123, v124
    v_max3_f32 v188, v188, v125, v126
    v_min3_f32 v190, v190, v125, v126
    v_max3_f32 v189, v128, v129, v130
    v_min3_f32 v191, v128, v129, v130
    v_max3_f32 v189, v189, v131, v132
    v_min3_f32 v191, v191, v131, v132
    v_max3_f32 v189, v189, v133, v134
    v_min3_f32 v191, v191, v133, v134
    s_nop 0
    v_permlane32_swap_b32 v188, v189
    v_permlane32_swap_b32 v190, v191
    v_max_f32 v188, v188, v189
    v_min_f32 v190, v190, v191
    v_mov_b32 v189, v188
    v_mov_b32 v191, v190
    s_nop 0
    v_permlane16_swap_b32 v188, v189
    v_permlane16_swap_b32 v190, v191
    v_max_f32 v188, v188, v189
    v_min_f32 v190, v190, v191
    v_mov_b32 v189, v188
    v_mov_b32 v191, v190
    s_nop 0
    v_permlane32_swap_b32 v188, v189
    v_permlane32_swap_b32 v190, v191
    v_mul_f32 v208, v188, v205
    v_mul_f32 v209, v190, v204
    v_mul_f32 v210, v189, v207
    v_mul_f32 v211, v191, v206
    v_pk_fma_f32 v[144:145], v[120:121], v[204:205], v[208:209] op_sel_hi:[0,1,1]
    v_pk_fma_f32 v[158:159], v[128:129], v[206:207], v[210:211] op_sel_hi:[0,1,1]
    v_pk_fma_f32 v[146:147], v[120:121], v[204:205], v[208:209] op_sel:[1,0,0]
    v_pk_fma_f32 v[160:161], v[128:129], v[206:207], v[210:211] op_sel:[1,0,0]
    v_pk_fma_f32 v[148:149], v[122:123], v[204:205], v[208:209] op_sel_hi:[0,1,1]
    v_pk_fma_f32 v[162:163], v[130:131], v[206:207], v[210:211] op_sel_hi:[0,1,1]
    v_pk_fma_f32 v[150:151], v[122:123], v[204:205], v[208:209] op_sel:[1,0,0]
    v_pk_fma_f32 v[164:165], v[130:131], v[206:207], v[210:211] op_sel:[1,0,0]
    v_pk_fma_f32 v[152:153], v[124:125], v[204:205], v[208:209] op_sel_hi:[0,1,1]
    v_pk_fma_f32 v[166:167], v[132:133], v[206:207], v[210:211] op_sel_hi:[0,1,1]
    v_pk_fma_f32 v[154:155], v[124:125], v[204:205], v[208:209] op_sel:[1,0,0]
    v_pk_fma_f32 v[168:169], v[132:133], v[206:207], v[210:211] op_sel:[1,0,0]
    v_pk_fma_f32 v[156:157], v[126:127], v[204:205], v[208:209] op_sel_hi:[0,1,1]
    v_pk_fma_f32 v[170:171], v[134:135], v[206:207], v[210:211] op_sel_hi:[0,1,1]
    v_exp_f32 v144, v144
    v_exp_f32 v158, v158
    v_exp_f32 v145, v145
    v_exp_f32 v159, v159
    v_exp_f32 v146, v146
    v_exp_f32 v160, v160
    v_exp_f32 v147, v147
    v_exp_f32 v161, v161
    v_exp_f32 v148, v148
    v_exp_f32 v162, v162
    v_exp_f32 v149, v149
    v_exp_f32 v163, v163
    v_exp_f32 v150, v150
    v_exp_f32 v164, v164
    v_exp_f32 v151, v151
    v_exp_f32 v165, v165
    v_exp_f32 v152, v152
    v_exp_f32 v166, v166
    v_exp_f32 v153, v153
    v_exp_f32 v167, v167
    v_exp_f32 v154, v154
    v_exp_f32 v168, v168
    v_exp_f32 v155, v155
    v_exp_f32 v169, v169
    v_exp_f32 v156, v156
    v_exp_f32 v170, v170
    v_exp_f32 v157, v157
    v_exp_f32 v171, v171
    v_pk_add_f32 v[188:189], v[144:145], v[146:147]
    v_pk_add_f32 v[190:191], v[158:159], v[160:161]
    v_pk_add_f32 v[188:189], v[188:189], v[148:149]
    v_pk_add_f32 v[190:191], v[190:191], v[162:163]
    v_pk_add_f32 v[188:189], v[188:189], v[150:151]
    v_pk_add_f32 v[190:191], v[190:191], v[164:165]
    v_pk_add_f32 v[188:189], v[188:189], v[152:153]
    v_pk_add_f32 v[190:191], v[190:191], v[166:167]
    v_pk_add_f32 v[188:189], v[188:189], v[154:155]
    v_pk_add_f32 v[190:191], v[190:191], v[168:169]
    v_pk_add_f32 v[188:189], v[188:189], v[156:157]
    v_pk_add_f32 v[190:191], v[190:191], v[170:171]
    s_nop 0
    v_permlane32_swap_b32 v188, v189
    v_permlane32_swap_b32 v190, v191
    v_add_f32 v188, v188, v189
    v_add_f32 v190, v190, v191
    v_mov_b32 v189, v188
    v_mov_b32 v191, v190
    s_nop 0
    v_permlane16_swap_b32 v188, v189
    v_permlane16_swap_b32 v190, v191
    v_add_f32 v188, v188, v189
    v_add_f32 v190, v190, v191
    v_mov_b32 v189, v188
    v_mov_b32 v191, v190
    s_nop 0
    v_permlane32_swap_b32 v188, v189
    v_permlane32_swap_b32 v190, v191
    v_rcp_f32 v188, v188
    v_rcp_f32 v189, v189
    v_rcp_f32 v190, v190
    v_rcp_f32 v191, v191
    v_pk_mul_f32 v[144:145], v[144:145], v[188:189]
    v_pk_mul_f32 v[146:147], v[146:147], v[188:189]
    v_pk_mul_f32 v[148:149], v[148:149], v[188:189]
    v_pk_mul_f32 v[150:151], v[150:151], v[188:189]
    v_pk_mul_f32 v[152:153], v[152:153], v[188:189]
    v_pk_mul_f32 v[154:155], v[154:155], v[188:189]
    v_pk_mul_f32 v[156:157], v[156:157], v[188:189]
    v_cvt_pk_bf16_f32 v232, v144, v146
    v_cvt_pk_bf16_f32 v233, v148, v150
    v_cvt_pk_bf16_f32 v234, v152, v154
    v_cvt_pk_bf16_f32 v235, v156, 0
    ds_write_b128 v220, v[232:235] offset:0
    v_cvt_pk_bf16_f32 v236, v145, v147
    v_cvt_pk_bf16_f32 v237, v149, v151
    v_cvt_pk_bf16_f32 v238, v153, v155
    v_cvt_pk_bf16_f32 v239, v157, 0
    ds_write_b128 v220, v[236:239] offset:8192
    v_pk_mul_f32 v[158:159], v[158:159], v[190:191]
    v_pk_mul_f32 v[160:161], v[160:161], v[190:191]
    v_pk_mul_f32 v[162:163], v[162:163], v[190:191]
    v_pk_mul_f32 v[164:165], v[164:165], v[190:191]
    v_pk_mul_f32 v[166:167], v[166:167], v[190:191]
    v_pk_mul_f32 v[168:169], v[168:169], v[190:191]
    v_pk_mul_f32 v[170:171], v[170:171], v[190:191]
    v_cvt_pk_bf16_f32 v224, v158, v160
    v_cvt_pk_bf16_f32 v225, v162, v164
    v_cvt_pk_bf16_f32 v226, v166, v168
    v_cvt_pk_bf16_f32 v227, v170, 0
    ds_write_b128 v220, v[224:227] offset:1024
    v_cvt_pk_bf16_f32 v228, v159, v161
    v_cvt_pk_bf16_f32 v229, v163, v165
    v_cvt_pk_bf16_f32 v230, v167, v169
    v_cvt_pk_bf16_f32 v231, v171, 0
    ds_write_b128 v220, v[228:231] offset:9216
    s_waitcnt vmcnt(0) lgkmcnt(0)
    s_barrier
    s_lshr_b32 s89, s56, 1
    s_lshl_b32 s89, s89, 10
    s_add_u32 s89, s89, s81
    s_add_u32 s89, s89, 8192
    s_lshr_b32 s88, s58, 1
    s_xor_b32 s88, s88, s56
    s_and_b32 s90, s88, 1
    s_cbranch_scc1 L_give_63
    buffer_load_dwordx4 v[204:207], v247, s[48:51], s89 offen sc1
L_give_63:
    ds_read_b64_tr_b16 v[164:165], v251 offset:0
    ds_read_b64_tr_b16 v[166:167], v251 offset:1024
    ds_read_b64_tr_b16 v[128:129], v250 offset:0
    ds_read_b64_tr_b16 v[130:131], v250 offset:1024
    ds_read_b64_tr_b16 v[132:133], v250 offset:8
    ds_read_b64_tr_b16 v[134:135], v250 offset:1032
    ds_read_b64_tr_b16 v[168:169], v251 offset:2048
    ds_read_b64_tr_b16 v[170:171], v251 offset:3072
    ds_read_b64_tr_b16 v[140:141], v250 offset:2048
    ds_read_b64_tr_b16 v[142:143], v250 offset:3072
    ds_read_b64_tr_b16 v[144:145], v250 offset:2056
    ds_read_b64_tr_b16 v[146:147], v250 offset:3080
    s_waitcnt lgkmcnt(8)
    v_mfma_f32_16x16x32_bf16 v[120:123], v[128:131], v[164:167], 0
    s_waitcnt lgkmcnt(6)
    v_mfma_f32_16x16x32_bf16 v[124:127], v[132:135], v[164:167], 0
    ds_read_b64_tr_b16 v[172:173], v251 offset:4096
    ds_read_b64_tr_b16 v[174:175], v251 offset:5120
    ds_read_b64_tr_b16 v[148:149], v250 offset:4096
    ds_read_b64_tr_b16 v[150:151], v250 offset:5120
    ds_read_b64_tr_b16 v[152:153], v250 offset:4104
    ds_read_b64_tr_b16 v[154:155], v250 offset:5128
    s_waitcnt lgkmcnt(8)
    v_mfma_f32_16x16x32_bf16 v[120:123], v[140:143], v[168:171], v[120:123]
    s_waitcnt lgkmcnt(6)
    v_mfma_f32_16x16x32_bf16 v[124:127], v[144:147], v[168:171], v[124:127]
    ds_read_b64_tr_b16 v[196:197], v251 offset:6144
    ds_read_b64_tr_b16 v[198:199], v251 offset:7168
    ds_read_b64_tr_b16 v[156:157], v250 offset:6144
    ds_read_b64_tr_b16 v[158:159], v250 offset:7168
    ds_read_b64_tr_b16 v[160:161], v250 offset:6152
    ds_read_b64_tr_b16 v[162:163], v250 offset:7176
    s_waitcnt lgkmcnt(8)
    v_mfma_f32_16x16x32_bf16 v[120:123], v[148:151], v[172:175], v[120:123]
    s_waitcnt lgkmcnt(6)
    v_mfma_f32_16x16x32_bf16 v[124:127], v[152:155], v[172:175], v[124:127]
    s_waitcnt lgkmcnt(2)
    v_mfma_f32_16x16x32_bf16 v[120:123], v[156:159], v[196:199], v[120:123]
    s_waitcnt lgkmcnt(0)
    v_mfma_f32_16x16x32_bf16 v[124:127], v[160:163], v[196:199], v[124:127]
    ds_read_b128 a[168:171], v1 offset:0
    ds_read_b128 a[172:175], v1 offset:1024
    s_cmp_eq_u32 s90, 1
    s_cbranch_scc1 L_give_62
    s_waitcnt vmcnt(0)
    v_xor_b32 v184, s62, v207
    v_and_b32 v184, v184, v248
    v_cmp_lt_u32 vcc, 0xffff, v184
    s_cbranch_vccnz L_take_64
    v_mfma_f32_16x16x32_bf16 v[120:123], a[238:241], v[204:207], v[120:123]
    v_mfma_f32_16x16x32_bf16 v[124:127], a[236:239], v[204:207], v[124:127]
    s_nop 6
    v_cvt_pk_bf16_f32 v188, v120, v121
    v_cvt_pk_bf16_f32 v189, v122, v123
    v_cvt_pk_bf16_f32 v190, v124, v125
    v_cvt_pk_bf16_f32 v191, v126, v127
    v_and_b32 v191, 0xffff, v191
    v_or_b32 v191, s62, v191
    buffer_store_dwordx4 v[188:191], v247, s[48:51], s80 offen sc1
    s_mov_b32 s90, 1
L_kept_65:
    ds_read_b128 a[176:179], v1 offset:2048
    ds_read_b128 a[180:183], v1 offset:3072
    ds_read_b128 a[184:187], v1 offset:4096
    ds_read_b128 a[188:191], v1 offset:5120
    s_waitcnt lgkmcnt(5)
    v_mfma_f32_16x16x32_bf16 v[112:115], a[168:171], a[0:3], 0
    v_add_u32 v186, s81, v249
    v_mfma_f32_16x16x32_bf16 v[136:139], a[168:171], a[4:7], 0
    s_waitcnt lgkmcnt(4)
    ds_read_b128 a[168:171], v1 offset:6144
    v_readlane_b32 s8, v186, 0
    v_mfma_f32_16x16x32_bf16 v[116:119], a[172:175], a[0:3], 0
    v_readlane_b32 s9, v186, 1
    v_readlane_b32 s10, v186, 2
    v_mfma_f32_16x16x32_bf16 v[140:143], a[172:175], a[4:7], 0
    s_waitcnt lgkmcnt(4)
    ds_read_b128 a[172:175], v1 offset:7168
    v_readlane_b32 s11, v186, 3
    v_mfma_f32_16x16x32_bf16 v[112:115], a[176:179], a[8:11], v[112:115]
    v_readlane_b32 s12, v186, 4
    v_readlane_b32 s13, v186, 5
    v_mfma_f32_16x16x32_bf16 v[136:139], a[176:179], a[12:15], v[136:139]
    s_waitcnt lgkmcnt(4)
    ds_read_b128 a[176:179], v1 offset:8192
    v_readlane_b32 s14, v186, 6
    v_mfma_f32_16x16x32_bf16 v[116:119], a[180:183], a[8:11], v[116:119]
    v_readlane_b32 s15, v186, 7
    v_mfma_f32_16x16x32_bf16 v[140:143], a[180:183], a[12:15], v[140:143]
    s_waitcnt lgkmcnt(4)
    ds_read_b128 a[180:183], v1 offset:9216
    v_mfma_f32_16x16x32_bf16 v[112:115], a[184:187], a[16:19], v[112:115]
    s_cmp_eq_u32 s90, 0
    s_cbranch_scc1 L_look_67
L_looked_68:
    v_mfma_f32_16x16x32_bf16 v[136:139], a[184:187], a[20:23], v[136:139]
    s_waitcnt lgkmcnt(4)
    ds_read_b128 a[184:187], v1 offset:10240
    v_mfma_f32_16x16x32_bf16 v[116:119], a[188:191], a[16:19], v[116:119]
    v_mfma_f32_16x16x32_bf16 v[140:143], a[188:191], a[20:23], v[140:143]
    s_waitcnt lgkmcnt(4)
    ds_read_b128 a[188:191], v1 offset:11264
    v_mfma_f32_16x16x32_bf16 v[112:115], a[168:171], a[24:27], v[112:115]
    v_mfma_f32_16x16x32_bf16 v[136:139], a[168:171], a[28:31], v[136:139]
    s_waitcnt lgkmcnt(4)
    ds_read_b128 a[168:171], v1 offset:12288
    v_mfma_f32_16x16x32_bf16 v[116:119], a[172:175], a[24:27], v[116:119]
    v_mfma_f32_16x16x32_bf16 v[140:143], a[172:175], a[28:31], v[140:143]
    s_waitcnt lgkmcnt(4)
    ds_read_b128 a[172:175], v1 offset:13312
    v_mfma_f32_16x16x32_bf16 v[112:115], a[176:179], a[32:35], v[112:115]
    s_cmp_eq_u32 s90, 0
    s_cbranch_scc1 L_look_69
L_looked_70:
    v_mfma_f32_16x16x32_bf16 v[136:139], a[176:179], a[36:39], v[136:139]
    s_waitcnt lgkmcnt(4)
    ds_read_b128 a[176:179], v1 offset:14336
    v_mfma_f32_16x16x32_bf16 v[116:119], a[180:183], a[32:35], v[116:119]
    v_mfma_f32_16x16x32_bf16 v[140:143], a[180:183], a[36:39], v[140:143]
    s_waitcnt lgkmcnt(4)
    ds_read_b128 a[180:183], v1 offset:15360
    v_mfma_f32_16x16x32_bf16 v[112:115], a[184:187], a[40:43], v[112:115]
    v_mfma_f32_16x16x32_bf16 v[136:139], a[184:187], a[44:47], v[136:139]
    s_waitcnt lgkmcnt(4)
    ds_read_b128 a[184:187], v1 offset:16384
    v_mfma_f32_16x16x32_bf16 v[116:119], a[188:191], a[40:43], v[116:119]
    v_mfma_f32_16x16x32_bf16 v[140:143], a[188:191], a[44:47], v[140:143]
    s_waitcnt lgkmcnt(4)
    ds_read_b128 a[188:191], v1 offset:17408
    v_mfma_f32_16x16x32_bf16 v[112:115], a[168:171], a[48:51], v[112:115]
    s_cmp_eq_u32 s90, 0
    s_cbranch_scc1 L_look_71
L_looked_72:
    v_mfma_f32_16x16x32_bf16 v[136:139], a[168:171], a[52:55], v[136:139]
    s_waitcnt lgkmcnt(4)
    ds_read_b128 a[168:171], v1 offset:18432
    v_mfma_f32_16x16x32_bf16 v[116:119], a[172:175], a[48:51], v[116:119]
    v_mfma_f32_16x16x32_bf16 v[140:143], a[172:175], a[52:55], v[140:143]
    s_waitcnt lgkmcnt(4)
    ds_read_b128 a[172:175], v1 offset:19456
    v_mfma_f32_16x16x32_bf16 v[112:115], a[176:179], a[56:59], v[112:115]
    v_mfma_f32_16x16x32_bf16 v[136:139], a[176:179], a[60:63], v[136:139]
    s_waitcnt lgkmcnt(4)
    ds_read_b128 a[176:179], v1 offset:20480
    v_mfma_f32_16x16x32_bf16 v[116:119], a[180:183], a[56:59], v[116:119]
    s_add_u32 m0, s6, 0
    v_mfma_f32_16x16x32_bf16 v[140:143], a[180:183], a[60:63], v[140:143]
    s_waitcnt lgkmcnt(4)
    ds_read_b128 a[180:183], v1 offset:21504
    s_add_u32 s93, s7, 0
    v_mfma_f32_16x16x32_bf16 v[112:115], a[184:187], a[64:67], v[112:115]
    s_cmp_eq_u32 s90, 0
    s_cbranch_scc1 L_look_73
L_looked_74:
    buffer_load_dwordx4 v246, s[40:43], s93 offen lds
    v_mfma_f32_16x16x32_bf16 v[136:139], a[184:187], a[68:71], v[136:139]
    s_waitcnt lgkmcnt(4)
    ds_read_b128 a[184:187], v1 offset:22528
    s_addk_i32 m0, 4096
    v_mfma_f32_16x16x32_bf16 v[116:119], a[188:191], a[64:67], v[116:119]
    s_addk_i32 s93, 28672
    v_mfma_f32_16x16x32_bf16 v[140:143], a[188:191], a[68:71], v[140:143]
    s_waitcnt lgkmcnt(4)
    ds_read_b128 a[188:191], v1 offset:23552
    buffer_load_dwordx4 v246, s[40:43], s93 offen lds
    v_mfma_f32_16x16x32_bf16 v[112:115], a[168:171], a[72:75], v[112:115]
    s_addk_i32 m0, 4096
    v_mfma_f32_16x16x32_bf16 v[136:139], a[168:171], a[76:79], v[136:139]
    s_waitcnt lgkmcnt(4)
    ds_read_b128 a[168:171], v1 offset:24576
    s_addk_i32 s93, 28672
    v_mfma_f32_16x16x32_bf16 v[116:119], a[172:175], a[72:75], v[116:119]
    buffer_load_dwordx4 v246, s[40:43], s93 offen lds
    v_mfma_f32_16x16x32_bf16 v[140:143], a[172:175], a[76:79], v[140:143]
    s_waitcnt lgkmcnt(4)
    ds_read_b128 a[172:175], v1 offset:25600
    s_addk_i32 m0, 4096
    v_mfma_f32_16x16x32_bf16 v[112:115], a[176:179], a[80:83], v[112:115]
    s_cmp_eq_u32 s90, 0
    s_cbranch_scc1 L_look_75
L_looked_76:
    s_addk_i32 s93, 28672
    v_mfma_f32_16x16x32_bf16 v[136:139], a[176:179], a[84:87], v[136:139]
    s_waitcnt lgkmcnt(4)
    ds_read_b128 a[176:179], v1 offset:26624
    buffer_load_dwordx4 v246, s[40:43], s93 offen lds
    v_mfma_f32_16x16x32_bf16 v[116:119], a[180:183], a[80:83], v[116:119]
    s_addk_i32 m0, 4096
    v_mfma_f32_16x16x32_bf16 v[140:143], a[180:183], a[84:87], v[140:143]
    s_waitcnt lgkmcnt(4)
    ds_read_b128 a[180:183], v1 offset:27648
    s_addk_i32 s93, 28672
    v_mfma_f32_16x16x32_bf16 v[112:115], a[184:187], a[88:91], v[112:115]
    buffer_load_dwordx4 v246, s[40:43], s93 offen lds
    v_mfma_f32_16x16x32_bf16 v[136:139], a[184:187], a[92:95], v[136:139]
    s_waitcnt lgkmcnt(4)
    s_addk_i32 m0, 4096
    v_mfma_f32_16x16x32_bf16 v[116:119], a[188:191], a[88:91], v[116:119]
    s_addk_i32 s93, 28672
    v_mfma_f32_16x16x32_bf16 v[140:143], a[188:191], a[92:95], v[140:143]
    s_waitcnt lgkmcnt(3)
    buffer_load_dwordx4 v246, s[40:43], s93 offen lds
    v_mfma_f32_16x16x32_bf16 v[112:115], a[168:171], a[96:99], v[112:115]
    s_cmp_eq_u32 s90, 0
    s_cbranch_scc1 L_look_77
L_looked_78:
    s_addk_i32 m0, 4096
    v_mfma_f32_16x16x32_bf16 v[136:139], a[168:171], a[100:103], v[136:139]
    s_waitcnt lgkmcnt(2)
    s_addk_i32 s93, 28672
    v_mfma_f32_16x16x32_bf16 v[116:119], a[172:175], a[96:99], v[116:119]
    buffer_load_dwordx4 v246, s[40:43], s93 offen lds
    v_mfma_f32_16x16x32_bf16 v[140:143], a[172:175], a[100:103], v[140:143]
    s_waitcnt lgkmcnt(1)
    s_addk_i32 m0, 4096
    v_mfma_f32_16x16x32_bf16 v[112:115], a[176:179], a[104:107], v[112:115]
    s_addk_i32 s93, 28672
    v_mfma_f32_16x16x32_bf16 v[136:139], a[176:179], a[108:111], v[136:139]
    s_waitcnt lgkmcnt(0)
    buffer_load_dwordx4 v246, s[40:43], s93 offen lds
    v_mfma_f32_16x16x32_bf16 v[116:119], a[180:183], a[104:107], v[116:119]
    v_mfma_f32_16x16x32_bf16 v[140:143], a[180:183], a[108:111], v[140:143]
    s_cmp_eq_u32 s90, 0
    s_cbranch_scc1 L_look_79
L_looked_80:
    s_cmp_lg_u32 s64, 0
    s_cbranch_scc1 L_cq2_81
    ds_read_b128 a[168:171], v1 offset:0
    ds_read_b128 a[172:175], v1 offset:1024
    ds_read_b128 a[176:179], v1 offset:2048
    ds_read_b128 a[180:183], v1 offset:3072
    ds_read_b128 a[184:187], v1 offset:4096
    ds_read_b128 a[188:191], v1 offset:5120
    s_waitcnt lgkmcnt(5)
    v_mfma_f32_16x16x32_bf16 v[88:91], a[168:171], a[232:235], 0
    s_waitcnt lgkmcnt(4)
    ds_read_b128 a[168:171], v1 offset:6144
    v_mfma_f32_16x16x32_bf16 v[92:95], a[172:175], a[232:235], 0
    s_waitcnt lgkmcnt(4)
    ds_read_b128 a[172:175], v1 offset:7168
    v_mfma_f32_16x16x32_bf16 v[88:91], a[176:179], a[232:235], v[88:91]
    s_waitcnt lgkmcnt(4)
    ds_read_b128 a[176:179], v1 offset:8192
    v_mfma_f32_16x16x32_bf16 v[92:95], a[180:183], a[232:235], v[92:95]
    s_waitcnt lgkmcnt(4)
    ds_read_b128 a[180:183], v1 offset:9216
    v_mfma_f32_16x16x32_bf16 v[88:91], a[184:187], a[232:235], v[88:91]
    s_waitcnt lgkmcnt(4)
    ds_read_b128 a[184:187], v1 offset:10240
    v_mfma_f32_16x16x32_bf16 v[92:95], a[188:191], a[232:235], v[92:95]
    s_waitcnt lgkmcnt(4)
    ds_read_b128 a[188:191], v1 offset:11264
    v_mfma_f32_16x16x32_bf16 v[88:91], a[168:171], a[232:235], v[88:91]
    s_waitcnt lgkmcnt(4)
    ds_read_b128 a[168:171], v1 offset:12288
    v_mfma_f32_16x16x32_bf16 v[92:95], a[172:175], a[232:235], v[92:95]
    s_waitcnt lgkmcnt(4)
    ds_read_b128 a[172:175], v1 offset:13312
    v_mfma_f32_16x16x32_bf16 v[88:91], a[176:179], a[232:235], v[88:91]
    s_waitcnt lgkmcnt(4)
    ds_read_b128 a[176:179], v1 offset:14336
    v_mfma_f32_16x16x32_bf16 v[92:95], a[180:183], a[232:235], v[92:95]
    s_waitcnt lgkmcnt(4)
    ds_read_b128 a[180:183], v1 offset:15360
    v_mfma_f32_16x16x32_bf16 v[88:91], a[184:187], a[232:235], v[88:91]
    s_waitcnt lgkmcnt(4)
    ds_read_b128 a[184:187], v1 offset:16384
    v_mfma_f32_16x16x32_bf16 v[92:95], a[188:191], a[232:235], v[92:95]
    s_waitcnt lgkmcnt(4)
    ds_read_b128 a[188:191], v1 offset:17408
    v_mfma_f32_16x16x32_bf16 v[88:91], a[168:171], a[232:235], v[88:91]
    s_waitcnt lgkmcnt(4)
    ds_read_b128 a[168:171], v1 offset:18432
    v_mfma_f32_16x16x32_bf16 v[92:95], a[172:175], a[232:235], v[92:95]
    s_waitcnt lgkmcnt(4)
    ds_read_b128 a[172:175], v1 offset:19456
    v_mfma_f32_16x16x32_bf16 v[88:91], a[176:179], a[232:235], v[88:91]
    s_waitcnt lgkmcnt(4)
    ds_read_b128 a[176:179], v1 offset:20480
    v_mfma_f32_16x16x32_bf16 v[92:95], a[180:183], a[232:235], v[92:95]
    s_waitcnt lgkmcnt(4)
    ds_read_b128 a[180:183], v1 offset:21504
    v_mfma_f32_16x16x32_bf16 v[88:91], a[184:187], a[232:235], v[88:91]
    s_waitcnt lgkmcnt(4)
    ds_read_b128 a[184:187], v1 offset:22528
    v_mfma_f32_16x16x32_bf16 v[92:95], a[188:191], a[232:235], v[92:95]
    s_waitcnt lgkmcnt(4)
    ds_read_b128 a[188:191], v1 offset:23552
    v_mfma_f32_16x16x32_bf16 v[88:91], a[168:171], a[232:235], v[88:91]
    s_waitcnt lgkmcnt(4)
    ds_read_b128 a[168:171], v1 offset:24576
    v_mfma_f32_16x16x32_bf16 v[92:95], a[172:175], a[232:235], v[92:95]
    s_waitcnt lgkmcnt(4)
    ds_read_b128 a[172:175], v1 offset:25600
    v_mfma_f32_16x16x32_bf16 v[88:91], a[176:179], a[232:235], v[88:91]
    s_waitcnt lgkmcnt(4)
    ds_read_b128 a[176:179], v1 offset:26624
    v_mfma_f32_16x16x32_bf16 v[92:95], a[180:183], a[232:235], v[92:95]
    s_waitcnt lgkmcnt(4)
    ds_read_b128 a[180:183], v1 offset:27648
    v_mfma_f32_16x16x32_bf16 v[88:91], a[184:187], a[232:235], v[88:91]
    s_waitcnt lgkmcnt(4)
    v_mfma_f32_16x16x32_bf16 v[92:95], a[188:191], a[232:235], v[92:95]
    s_waitcnt lgkmcnt(3)
    v_mfma_f32_16x16x32_bf16 v[88:91], a[168:171], a[232:235], v[88:91]
    s_waitcnt lgkmcnt(2)
    v_mfma_f32_16x16x32_bf16 v[92:95], a[172:175], a[232:235], v[92:95]
    s_waitcnt lgkmcnt(1)
    v_mfma_f32_16x16x32_bf16 v[88:91], a[176:179], a[232:235], v[88:91]
    s_waitcnt lgkmcnt(0)
    v_mfma_f32_16x16x32_bf16 v[92:95], a[180:183], a[232:235], v[92:95]
    s_nop 7
L_cq2_81:
    v_pk_fma_f32 v[136:137], v[88:89], v[180:181], v[136:137] op_sel_hi:[1,0,1]
    v_pk_fma_f32 v[138:139], v[90:91], v[180:181], v[138:139] op_sel_hi:[1,0,1]
    v_pk_fma_f32 v[140:141], v[92:93], v[180:181], v[140:141] op_sel_hi:[1,0,1]
    v_pk_fma_f32 v[142:143], v[94:95], v[180:181], v[142:143] op_sel_hi:[1,0,1]
    v_cvt_pk_bf16_f32 v200, v136, v137
    v_cvt_pk_bf16_f32 v201, v138, v139
    v_cvt_pk_bf16_f32 v202, v140, v141
    v_cvt_pk_bf16_f32 v203, v142, v143
    v_pk_fma_f32 v[112:113], v[88:89], v[176:177], v[112:113] op_sel_hi:[1,0,1]
    v_pk_fma_f32 v[114:115], v[90:91], v[176:177], v[114:115] op_sel_hi:[1,0,1]
    v_pk_fma_f32 v[116:117], v[92:93], v[176:177], v[116:117] op_sel_hi:[1,0,1]
    v_pk_fma_f32 v[118:119], v[94:95], v[176:177], v[118:119] op_sel_hi:[1,0,1]
    v_cvt_pk_bf16_f32 v196, v112, v113
    v_cvt_pk_bf16_f32 v197, v114, v115
    v_cvt_pk_bf16_f32 v198, v116, v117
    v_cvt_pk_bf16_f32 v199, v118, v119
    s_nop 1
    v_mfma_f32_16x16x32_bf16 v[120:123], a[242:245], v[196:199], 0
    v_mfma_f32_16x16x32_bf16 v[124:127], a[246:249], v[196:199], 0
    v_mfma_f32_16x16x32_bf16 v[128:131], a[242:245], v[200:203], 0
    v_mfma_f32_16x16x32_bf16 v[132:135], a[246:249], v[200:203], 0
    v_mov_b32 v204, v179
    v_sub_f32 v205, 0, v179
    v_mov_b32 v206, v183
    v_sub_f32 v207, 0, v183
    s_nop 0
    v_max3_f32 v188, v120, v121, v122
    v_min3_f32 v190, v120, v121, v122
    v_max3_f32 v188, v188, v123, v124
    v_min3_f32 v190, v190, v123, v124
    v_max3_f32 v188, v188, v125, v126
    v_min3_f32 v190, v190, v125, v126
    v_max3_f32 v189, v128, v129, v130
    v_min3_f32 v191, v128, v129, v130
    v_max3_f32 v189, v189, v131, v132
    v_min3_f32 v191, v191, v131, v132
    v_max3_f32 v189, v189, v133, v134
    v_min3_f32 v191, v191, v133, v134
    s_nop 0
    v_permlane32_swap_b32 v188, v189
    v_permlane32_swap_b32 v190, v191
    v_max_f32 v188, v188, v189
    v_min_f32 v190, v190, v191
    v_mov_b32 v189, v188
    v_mov_b32 v191, v190
    s_nop 0
    v_permlane16_swap_b32 v188, v189
    v_permlane16_swap_b32 v190, v191
    v_max_f32 v188, v188, v189
    v_min_f32 v190, v190, v191
    v_mov_b32 v189, v188
    v_mov_b32 v191, v190
    s_nop 0
    v_permlane32_swap_b32 v188, v189
    v_permlane32_swap_b32 v190, v191
    v_mul_f32 v208, v188, v205
    v_mul_f32 v209, v190, v204
    v_mul_f32 v210, v189, v207
    v_mul_f32 v211, v191, v206
    v_pk_fma_f32 v[144:145], v[120:121], v[204:205], v[208:209] op_sel_hi:[0,1,1]
    v_pk_fma_f32 v[158:159], v[128:129], v[206:207], v[210:211] op_sel_hi:[0,1,1]
    v_pk_fma_f32 v[146:147], v[120:121], v[204:205], v[208:209] op_sel:[1,0,0]
    v_pk_fma_f32 v[160:161], v[128:129], v[206:207], v[210:211] op_sel:[1,0,0]
    v_pk_fma_f32 v[148:149], v[122:123], v[204:205], v[208:209] op_sel_hi:[0,1,1]
    v_pk_fma_f32 v[162:163], v[130:131], v[206:207], v[210:211] op_sel_hi:[0,1,1]
    v_pk_fma_f32 v[150:151], v[122:123], v[204:205], v[208:209] op_sel:[1,0,0]
    v_pk_fma_f32 v[164:165], v[130:131], v[206:207], v[210:211] op_sel:[1,0,0]
    v_pk_fma_f32 v[152:153], v[124:125], v[204:205], v[208:209] op_sel_hi:[0,1,1]
    v_pk_fma_f32 v[166:167], v[132:133], v[206:207], v[210:211] op_sel_hi:[0,1,1]
    v_pk_fma_f32 v[154:155], v[124:125], v[204:205], v[208:209] op_sel:[1,0,0]
    v_pk_fma_f32 v[168:169], v[132:133], v[206:207], v[210:211] op_sel:[1,0,0]
    v_pk_fma_f32 v[156:157], v[126:127], v[204:205], v[208:209] op_sel_hi:[0,1,1]
    v_pk_fma_f32 v[170:171], v[134:135], v[206:207], v[210:211] op_sel_hi:[0,1,1]
    v_exp_f32 v144, v144
    v_exp_f32 v158, v158
    v_exp_f32 v145, v145
    v_exp_f32 v159, v159
    buffer_load_dwordx4 a[0:3], v247, s[48:51], s8 offen sc1
    v_exp_f32 v146, v146
    v_exp_f32 v160, v160
    buffer_load_dwordx4 a[4:7], v247, s[48:51], s9 offen sc1
    v_exp_f32 v147, v147
    v_exp_f32 v161, v161
    buffer_load_dwordx4 a[8:11], v247, s[48:51], s10 offen sc1
    v_exp_f32 v148, v148
    v_exp_f32 v162, v162
    buffer_load_dwordx4 a[12:15], v247, s[48:51], s11 offen sc1
    v_exp_f32 v149, v149
    v_exp_f32 v163, v163
    buffer_load_dwordx4 a[16:19], v247, s[48:51], s12 offen sc1
    v_exp_f32 v150, v150
    v_exp_f32 v164, v164
    buffer_load_dwordx4 a[20:23], v247, s[48:51], s13 offen sc1
    v_exp_f32 v151, v151
    v_exp_f32 v165, v165
    buffer_load_dwordx4 a[24:27], v247, s[48:51], s14 offen sc1
    v_exp_f32 v152, v152
    v_exp_f32 v166, v166
    buffer_load_dwordx4 a[28:31], v247, s[48:51], s15 offen sc1
    v_exp_f32 v153, v153
    v_exp_f32 v167, v167
    v_exp_f32 v154, v154
    v_exp_f32 v168, v168
    v_exp_f32 v155, v155
    v_exp_f32 v169, v169
    v_exp_f32 v156, v156
    v_exp_f32 v170, v170
    v_exp_f32 v157, v157
    v_exp_f32 v171, v171
    v_pk_add_f32 v[188:189], v[144:145], v[146:147]
    v_pk_add_f32 v[190:191], v[158:159], v[160:161]
    v_pk_add_f32 v[188:189], v[188:189], v[148:149]
    v_pk_add_f32 v[190:191], v[190:191], v[162:163]
    v_pk_add_f32 v[188:189], v[188:189], v[150:151]
    v_pk_add_f32 v[190:191], v[190:191], v[164:165]
    v_pk_add_f32 v[188:189], v[188:189], v[152:153]
    v_pk_add_f32 v[190:191], v[190:191], v[166:167]
    v_pk_add_f32 v[188:189], v[188:189], v[154:155]
    v_pk_add_f32 v[190:191], v[190:191], v[168:169]
    v_pk_add_f32 v[188:189], v[188:189], v[156:157]
    v_pk_add_f32 v[190:191], v[190:191], v[170:171]
    s_nop 0
    v_permlane32_swap_b32 v188, v189
    v_permlane32_swap_b32 v190, v191
    v_add_f32 v188, v188, v189
    v_add_f32 v190, v190, v191
    v_mov_b32 v189, v188
    v_mov_b32 v191, v190
    s_nop 0
    v_permlane16_swap_b32 v188, v189
    v_permlane16_swap_b32 v190, v191
    v_add_f32 v188, v188, v189
    v_add_f32 v190, v190, v191
    v_mov_b32 v189, v188
    v_mov_b32 v191, v190
    s_nop 0
    v_permlane32_swap_b32 v188, v189
    v_permlane32_swap_b32 v190, v191
    v_rcp_f32 v188, v188
    v_rcp_f32 v189, v189
    v_rcp_f32 v190, v190
    v_rcp_f32 v191, v191
    v_pk_mul_f32 v[144:145], v[144:145], v[188:189]
    v_pk_mul_f32 v[146:147], v[146:147], v[188:189]
    v_pk_mul_f32 v[148:149], v[148:149], v[188:189]
    v_pk_mul_f32 v[150:151], v[150:151], v[188:189]
    v_pk_mul_f32 v[152:153], v[152:153], v[188:189]
    v_pk_mul_f32 v[154:155], v[154:155], v[188:189]
    v_pk_mul_f32 v[156:157], v[156:157], v[188:189]
    v_cvt_pk_bf16_f32 v232, v144, v146
    v_cvt_pk_bf16_f32 v233, v148, v150
    v_cvt_pk_bf16_f32 v234, v152, v154
    v_cvt_pk_bf16_f32 v235, v156, 0
    v_cvt_pk_bf16_f32 v236, v145, v147
    v_cvt_pk_bf16_f32 v237, v149, v151
    v_cvt_pk_bf16_f32 v238, v153, v155
    v_cvt_pk_bf16_f32 v239, v157, 0
    v_pk_mul_f32 v[158:159], v[158:159], v[190:191]
    v_pk_mul_f32 v[160:161], v[160:161], v[190:191]
    v_pk_mul_f32 v[162:163], v[162:163], v[190:191]
    v_pk_mul_f32 v[164:165], v[164:165], v[190:191]
    v_pk_mul_f32 v[166:167], v[166:167], v[190:191]
    v_pk_mul_f32 v[168:169], v[168:169], v[190:191]
    v_pk_mul_f32 v[170:171], v[170:171], v[190:191]
    v_cvt_pk_bf16_f32 v224, v158, v160
    v_cvt_pk_bf16_f32 v225, v162, v164
    v_cvt_pk_bf16_f32 v226, v166, v168
    v_cvt_pk_bf16_f32 v227, v170, 0
    v_cvt_pk_bf16_f32 v228, v159, v161
    v_cvt_pk_bf16_f32 v229, v163, v165
    v_cvt_pk_bf16_f32 v230, v167, v169
    v_cvt_pk_bf16_f32 v231, v171, 0
    s_mov_b32 s90, 0
L_ggo_82:
    s_cmp_lg_u32 s64, s90
    s_cbranch_scc1 L_badone_84
    ds_read_b128 a[112:115], v244 offset:28672
    ds_write_b128 v244, a[116:119] offset:28672
    ds_read_b128 a[116:119], v244 offset:29696
    ds_write_b128 v244, a[120:123] offset:29696
    ds_read_b128 a[120:123], v244 offset:30720
    ds_write_b128 v244, a[124:127] offset:30720
    ds_read_b128 a[124:127], v244 offset:31744
    ds_write_b128 v244, a[128:131] offset:31744
    ds_read_b128 a[128:131], v244 offset:32768
    ds_write_b128 v244, a[132:135] offset:32768
    ds_read_b128 a[132:135], v244 offset:33792
    ds_write_b128 v244, a[136:139] offset:33792
    ds_read_b128 a[136:139], v244 offset:34816
    ds_write_b128 v244, a[140:143] offset:34816
L_badone_84:
    s_mov_b32 s90, 9
    v_add_u32 v220, 32768, v253
    v_add_u32 v221, 151552, v1
    s_waitcnt vmcnt(7)
    v_mfma_f32_16x16x32_bf16 v[176:179], a[238:241], a[0:3], 0
    v_accvgpr_read_b32 v112, a3
    v_mfma_f32_16x16x32_bf16 v[180:183], a[236:239], a[0:3], 0
    s_waitcnt vmcnt(6)
    v_mfma_f32_16x16x32_bf16 v[176:179], a[238:241], a[4:7], v[176:179]
    v_accvgpr_read_b32 v113, a7
    v_min_u32 v184, v112, v113
    v_mfma_f32_16x16x32_bf16 v[180:183], a[236:239], a[4:7], v[180:183]
    s_waitcnt vmcnt(5)
    v_max_u32 v185, v112, v113
    v_mfma_f32_16x16x32_bf16 v[176:179], a[238:241], a[8:11], v[176:179]
    v_accvgpr_read_b32 v114, a11
    v_mfma_f32_16x16x32_bf16 v[180:183], a[236:239], a[8:11], v[180:183]
    s_waitcnt vmcnt(4)
    v_mfma_f32_16x16x32_bf16 v[176:179], a[238:241], a[12:15], v[176:179]
    v_accvgpr_read_b32 v115, a15
    v_min3_u32 v184, v184, v114, v115
    v_mfma_f32_16x16x32_bf16 v[180:183], a[236:239], a[12:15], v[180:183]
    s_waitcnt vmcnt(3)
    v_max3_u32 v185, v185, v114, v115
    v_mfma_f32_16x16x32_bf16 v[176:179], a[238:241], a[16:19], v[176:179]
    v_accvgpr_read_b32 v116, a19
    v_mfma_f32_16x16x32_bf16 v[180:183], a[236:239], a[16:19], v[180:183]
    s_waitcnt vmcnt(2)
    v_mfma_f32_16x16x32_bf16 v[176:179], a[238:241], a[20:23], v[176:179]
    v_accvgpr_read_b32 v117, a23
    v_min3_u32 v184, v184, v116, v117
    v_mfma_f32_16x16x32_bf16 v[180:183], a[236:239], a[20:23], v[180:183]
    s_waitcnt vmcnt(1)
    v_max3_u32 v185, v185, v116, v117
    v_mfma_f32_16x16x32_bf16 v[176:179], a[238:241], a[24:27], v[176:179]
    v_accvgpr_read_b32 v118, a27
    v_mfma_f32_16x16x32_bf16 v[180:183], a[236:239], a[24:27], v[180:183]
    s_waitcnt vmcnt(0)
    v_mfma_f32_16x16x32_bf16 v[176:179], a[238:241], a[28:31], v[176:179]
    v_accvgpr_read_b32 v119, a31
    v_min3_u32 v184, v184, v118, v119
    v_mfma_f32_16x16x32_bf16 v[180:183], a[236:239], a[28:31], v[180:183]
    v_max3_u32 v185, v185, v118, v119
    v_xor_b32 v184, s62, v184
    v_xor_b32 v185, s62, v185
    v_or_b32 v184, v184, v185
    v_and_b32 v184, v184, v248
    v_cmp_lt_u32 vcc, 0xffff, v184
    s_cbranch_vccnz L_gslow_83
    v_cvt_pk_bf16_f32 v112, v176, v177
    v_cvt_pk_bf16_f32 v113, v178, v179
    v_cvt_pk_bf16_f32 v114, v180, v181
    v_cvt_pk_bf16_f32 v115, v182, v183
    ds_write_b128 v220, v[112:115]
    s_waitcnt lgkmcnt(0)
    s_barrier
    ds_read_b128 a[16:19], v27 offset:0
    ds_read_b128 a[0:3], v221 offset:0
    ds_read_b128 a[4:7], v221 offset:1024
    ds_read_b128 a[20:23], v27 offset:2048
    ds_read_b128 a[8:11], v221 offset:2048
    ds_read_b128 a[12:15], v221 offset:3072
    s_waitcnt lgkmcnt(5)
    v_mfma_f32_16x16x32_bf16 v[160:163], a[16:19], v[232:235], 0
    v_mfma_f32_16x16x32_bf16 v[164:167], a[16:19], v[224:227], 0
    s_waitcnt lgkmcnt(4)
    v_mfma_f32_16x16x32_bf16 v[144:147], a[0:3], v[232:235], 0
    s_waitcnt lgkmcnt(3)
    v_mfma_f32_16x16x32_bf16 v[148:151], a[4:7], v[232:235], 0
    v_mfma_f32_16x16x32_bf16 v[152:155], a[0:3], v[224:227], 0
    v_mfma_f32_16x16x32_bf16 v[156:159], a[4:7], v[224:227], 0
    s_waitcnt lgkmcnt(2)
    v_mfma_f32_16x16x32_bf16 v[160:163], a[20:23], v[236:239], v[160:163]
    v_mfma_f32_16x16x32_bf16 v[164:167], a[20:23], v[228:231], v[164:167]
    s_waitcnt lgkmcnt(1)
    v_mfma_f32_16x16x32_bf16 v[144:147], a[8:11], v[236:239], v[144:147]
    s_waitcnt lgkmcnt(0)
    v_mfma_f32_16x16x32_bf16 v[148:151], a[12:15], v[236:239], v[148:151]
    v_mfma_f32_16x16x32_bf16 v[152:155], a[8:11], v[228:231], v[152:155]
    v_mfma_f32_16x16x32_bf16 v[156:159], a[12:15], v[228:231], v[156:159]
    s_mov_b32 s65, 0
    s_mov_b64 s[24:25], s[40:41]
    s_add_u32 s64, s64, 1
    s_add_u32 s80, s80, 1048576
    s_add_u32 s81, s81, 1048576
    s_add_u32 s77, s77, 262144
    v_add_f32 v160, 0x358637bd, v160
    v_add_f32 v164, 0x358637bd, v164
    s_add_u32 s89, s70, 16384
    s_lshl_b32 s88, s66, 4
    s_or_b32 s88, s88, s61
    v_rcp_f32 v160, v160
    v_rcp_f32 v164, v164
    v_mov_b32 v255, s88
    s_cmp_eq_u32 s63, 0
    v_pk_mul_f32 v[144:145], v[144:145], v[160:161] op_sel_hi:[1,0]
    v_pk_mul_f32 v[146:147], v[146:147], v[160:161] op_sel_hi:[1,0]
    v_pk_mul_f32 v[148:149], v[148:149], v[160:161] op_sel_hi:[1,0]
    v_pk_mul_f32 v[150:151], v[150:151], v[160:161] op_sel_hi:[1,0]
    v_cvt_pk_bf16_f32 v116, v144, v145
    v_cvt_pk_bf16_f32 v117, v146, v147
    v_cvt_pk_bf16_f32 v118, v148, v149
    v_cvt_pk_bf16_f32 v119, v150, v151
    s_cbranch_scc1 L_ofar_85
    buffer_store_dwordx2 v[116:117], v4, s[48:51], s70 offen
    buffer_store_dwordx2 v[118:119], v5, s[48:51], s70 offen
    v_pk_mul_f32 v[152:153], v[152:153], v[164:165] op_sel_hi:[1,0]
    v_pk_mul_f32 v[154:155], v[154:155], v[164:165] op_sel_hi:[1,0]
    v_pk_mul_f32 v[156:157], v[156:157], v[164:165] op_sel_hi:[1,0]
    v_pk_mul_f32 v[158:159], v[158:159], v[164:165] op_sel_hi:[1,0]
    v_cvt_pk_bf16_f32 v120, v152, v153
    v_cvt_pk_bf16_f32 v121, v154, v155
    v_cvt_pk_bf16_f32 v122, v156, v157
    v_cvt_pk_bf16_f32 v123, v158, v159
    buffer_store_dwordx2 v[120:121], v4, s[48:51], s89 offen
    buffer_store_dwordx2 v[122:123], v5, s[48:51], s89 offen
L_ostored_86:
    s_cmp_lg_u32 s64, 1
    s_cbranch_scc1 L_badone_87
    ds_read_b128 a[140:143], v244 offset:57344
    ds_write_b128 v244, a[144:147] offset:57344
    ds_read_b128 a[144:147], v244 offset:58368
    ds_write_b128 v244, a[148:151] offset:58368
    ds_read_b128 a[148:151], v244 offset:59392
    ds_write_b128 v244, a[152:155] offset:59392
    ds_read_b128 a[152:155], v244 offset:60416
    ds_write_b128 v244, a[156:159] offset:60416
    ds_read_b128 a[156:159], v244 offset:61440
    ds_write_b128 v244, a[160:163] offset:61440
    ds_read_b128 a[160:163], v244 offset:62464
    ds_write_b128 v244, a[164:167] offset:62464
    ds_read_b128 a[164:167], v244 offset:63488
    ds_write_b128 v244, a[200:203] offset:63488
L_badone_87:
    s_waitcnt vmcnt(0)
    s_cmp_eq_u32 s63, 0
    s_cbranch_scc1 L_pubslow_88
    s_mov_b64 exec, 1
    buffer_store_dword v255, off, s[48:51], s75
L_pubdone_89:
    s_mov_b64 exec, -1
    s_branch L_p
L_final:
    v_cvt_pk_bf16_f32 v112, v48, v49
    v_cvt_pk_bf16_f32 v113, v50, v51
    ds_write_b64 v132, v[112:113]
    v_cvt_pk_bf16_f32 v114, v52, v53
    v_cvt_pk_bf16_f32 v115, v54, v55
    ds_write_b64 v133, v[114:115]
    v_cvt_pk_bf16_f32 v116, v56, v57
    v_cvt_pk_bf16_f32 v117, v58, v59
    ds_write_b64 v134, v[116:117]
    v_cvt_pk_bf16_f32 v118, v60, v61
    v_cvt_pk_bf16_f32 v119, v62, v63
    ds_write_b64 v135, v[118:119]
    s_waitcnt lgkmcnt(0)
    ds_read_b128 v[124:127], v120 offset:0
    ds_read_b128 v[128:131], v120 offset:1024
    s_waitcnt lgkmcnt(1)
    buffer_store_dwordx4 v[124:127], v12, s[44:47], s85 offen
    s_waitcnt lgkmcnt(0)
    buffer_store_dwordx4 v[128:131], v12, s[44:47], s90 offen
L_fin2:
    s_or_b32 s88, s2, s58
    s_cmp_lg_u32 s88, 0
    s_cbranch_scc1 L_end
    s_add_u32 s88, s86, 0x10100
    v_mov_b32 v120, s88
    s_mov_b64 exec, 1
    buffer_store_dword v120, off, s[48:51], 0
    s_endpgm
L_pend_17:
    s_lshl_b32 s89, s59, 2
    s_add_u32 s89, s89, s79
    s_lshl_b32 s88, s66, 4
    s_or_b32 s88, s88, s61
    v_mov_b32 v255, s88
    s_mov_b64 exec, 1
    buffer_store_dword v255, off, s[48:51], s89 offset:128 sc1
    s_mov_b64 exec, -1
    s_mov_b32 s84, 0
    s_branch L_nopend_18
L_qslow_19:
    s_cmp_eq_u32 s66, 1
    s_cselect_b32 s88, 0, s63
    s_cmp_eq_u32 s88, 0
    s_cbranch_scc1 L_qgen_91
    buffer_load_dword v114, v14, s[48:51], 0 offen sc1
    s_nop 7
L_qfast_90:
    buffer_load_dword v113, v14, s[48:51], 0 offen sc1
    s_waitcnt vmcnt(1)
    v_cmp_ne_u32 vcc, v112, v114
    s_cbranch_vccz L_qpass_16
    buffer_load_dword v114, v14, s[48:51], 0 offen sc1
    s_waitcnt vmcnt(1)
    v_cmp_ne_u32 vcc, v112, v113
    s_cbranch_vccz L_qpass_16
    s_sub_u32 s67, s67, 1
    s_cbranch_scc1 L_end
    s_branch L_qfast_90
L_qgen_91:
    s_cmp_eq_u32 s63, 0
    s_cbranch_scc1 L_qagain_20m
    v_not_b32 v115, v15
    v_and_b32 v116, v113, v15
    v_and_b32 v115, v113, v115
    v_cmp_ne_u32 s[96:97], 0, v115
    v_cmp_eq_u32 vcc, 0, v116
    s_nop 1
    s_cmp_eq_u64 s[96:97], 0
    s_cbranch_scc1 L_qagain_20
    s_and_b32 s88, vcc_lo, vcc_hi
    s_andn2_b32 s88, 0xffff0000, s88
    s_cbranch_scc1 L_qagain_20
    s_mov_b32 s63, 0
    s_add_u32 s74, s74, 32768
    s_add_u32 s75, s75, 32768
    s_add_u32 s76, s76, 32768
    v_lshlrev_b32 v115, 11, v30
    v_add_u32 v14, v115, v14
    s_cmp_eq_u32 s59, 7
    s_cbranch_scc1 L_qagain_20
    buffer_wbl2 sc1
    s_waitcnt vmcnt(0)
    s_or_b32 s88, s61, 16
    v_mov_b32 v255, s88
    s_mov_b64 exec, 1
    buffer_store_dword v255, off, s[48:51], s74 sc1
    s_mov_b64 exec, -1
    s_branch L_qagain_20
L_qagain_20m:
    v_and_b32 v116, v113, v15
    v_cmp_ne_u32 vcc, 0, v116
    s_cbranch_vccz L_qpass_16
L_qagain_20:
    s_sub_u32 s67, s67, 1
    s_cbranch_scc1 L_end
    s_branch L_qpoll_15
L_hslow_23:
    s_sub_u32 s67, s67, 1
    s_cbranch_scc1 L_end
    buffer_load_dword v194, v252, s[48:51], 0 offen sc1
    s_waitcnt vmcnt(0)
    v_cmp_ne_u32 vcc, v195, v194
    s_cbranch_vccnz L_hslow_23
    s_branch L_hback_24
L_ofar_25:
    buffer_store_dwordx2 v[168:169], v4, s[48:51], s70 offen sc1
    buffer_store_dwordx2 v[170:171], v5, s[48:51], s70 offen sc1
    v_pk_mul_f32 v[152:153], v[152:153], v[164:165] op_sel_hi:[1,0]
    v_pk_mul_f32 v[154:155], v[154:155], v[164:165] op_sel_hi:[1,0]
    v_pk_mul_f32 v[156:157], v[156:157], v[164:165] op_sel_hi:[1,0]
    v_pk_mul_f32 v[158:159], v[158:159], v[164:165] op_sel_hi:[1,0]
    v_cvt_pk_bf16_f32 v172, v152, v153
    v_cvt_pk_bf16_f32 v173, v154, v155
    v_cvt_pk_bf16_f32 v174, v156, v157
    v_cvt_pk_bf16_f32 v175, v158, v159
    buffer_store_dwordx2 v[172:173], v4, s[48:51], s89 offen sc1
    buffer_store_dwordx2 v[174:175], v5, s[48:51], s89 offen sc1
    s_branch L_ostored_26
L_pubslow_27:
    s_waitcnt vmcnt(0)
    buffer_wbl2 sc1
    s_waitcnt vmcnt(0)
    s_mov_b64 exec, 1
    buffer_store_dword v255, off, s[48:51], s75 sc1
    s_branch L_pubdone_28
L_ppoll_29:
    buffer_load_dword v112, v16, s[48:51], s76 offen sc1
    s_nop 7
L_ppoll_29l:
    buffer_load_dword v113, v16, s[48:51], s76 offen sc1
    s_waitcnt vmcnt(1)
    v_cmp_ne_u32 vcc, s88, v112
    s_cbranch_vccz L_ppass_30
    buffer_load_dword v112, v16, s[48:51], s76 offen sc1
    s_waitcnt vmcnt(1)
    v_cmp_ne_u32 vcc, s88, v113
    s_cbranch_vccz L_ppass_30
    s_sub_u32 s67, s67, 1
    s_cbranch_scc1 L_end
    s_branch L_ppoll_29l
L_pwb_33:
    s_cmp_eq_u32 s66, 4
    s_cbranch_scc1 L_mx4_92
    ds_read_b128 a[200:203], v244 offset:0
    ds_write_b128 v244, a[204:207] offset:0
    ds_read_b128 a[204:207], v244 offset:1024
    ds_write_b128 v244, a[208:211] offset:1024
    ds_read_b128 a[208:211], v244 offset:2048
    ds_write_b128 v244, a[212:215] offset:2048
    ds_read_b128 a[212:215], v244 offset:3072
    ds_write_b128 v244, a[216:219] offset:3072
L_badone_93:
    s_branch L_pwbd_34
L_mx4_92:
    ds_write_b128 v244, a[200:203] offset:0
    ds_write_b128 v244, a[204:207] offset:1024
    ds_write_b128 v244, a[208:211] offset:2048
    ds_write_b128 v244, a[212:215] offset:3072
    ds_write_b128 v244, a[216:219] offset:4096
    ds_write_b128 v244, a[220:223] offset:5120
    ds_write_b128 v244, a[224:227] offset:6144
    s_branch L_pwbd_34
L_pubslow_35:
    s_waitcnt vmcnt(0)
    buffer_wbl2 sc1
    s_waitcnt vmcnt(0)
    s_mov_b64 exec, 1
    buffer_store_dword v255, off, s[48:51], s74 sc1
    s_branch L_pubdone_36
L_nohalo_31:
    s_add_u32 s89, s89, 16384
    s_mov_b32 s96, 0xff00ff00
    s_mov_b32 s97, 0xff00ff00
    s_mov_b64 exec, s[96:97]
    buffer_store_dwordx4 v[112:115], v243, s[48:51], s89 offen sc1
    buffer_store_dwordx4 v[116:119], v243, s[48:51], s89 offen offset:512 sc1
    s_lshl_b32 s89, s59, 7
    s_add_u32 s89, s89, s77
    s_add_u32 s89, s89, 30720
    s_mov_b64 exec, 0xffff
    buffer_store_dwordx2 v[124:125], v26, s[48:51], s89 offen sc1
    s_mov_b64 exec, -1
    ds_read_b128 a[200:203], v244 offset:0
    ds_write_b128 v244, a[204:207] offset:0
    ds_read_b128 a[204:207], v244 offset:1024
    ds_write_b128 v244, a[208:211] offset:1024
    ds_read_b128 a[208:211], v244 offset:2048
    ds_write_b128 v244, a[212:215] offset:2048
    ds_read_b128 a[212:215], v244 offset:3072
    ds_write_b128 v244, a[216:219] offset:3072
L_badone_94:
    s_waitcnt vmcnt(3)
    s_branch L_pub_32
L_pidle:
    s_cmp_eq_u32 s66, 4
    s_cbranch_scc1 L_fin2
    s_add_u32 s66, s66, 1
    s_cmp_lt_u32 s66, 3
    s_cbranch_scc1 L_pnext
    s_cmp_eq_u32 s66, 4
    s_cbranch_scc1 L_mx4_95
    ds_read_b128 a[200:203], v244 offset:0
    ds_write_b128 v244, a[204:207] offset:0
    ds_read_b128 a[204:207], v244 offset:1024
    ds_write_b128 v244, a[208:211] offset:1024
    ds_read_b128 a[208:211], v244 offset:2048
    ds_write_b128 v244, a[212:215] offset:2048
    ds_read_b128 a[212:215], v244 offset:3072
    ds_write_b128 v244, a[216:219] offset:3072
L_badone_96:
    s_branch L_pnext
L_mx4_95:
    ds_write_b128 v244, a[200:203] offset:0
    ds_write_b128 v244, a[204:207] offset:1024
    ds_write_b128 v244, a[208:211] offset:2048
    ds_write_b128 v244, a[212:215] offset:3072
    ds_write_b128 v244, a[216:219] offset:4096
    ds_write_b128 v244, a[220:223] offset:5120
    ds_write_b128 v244, a[224:227] offset:6144
    s_branch L_pnext
L_pend_39:
    s_lshl_b32 s89, s59, 2
    s_add_u32 s89, s89, s79
    s_lshl_b32 s88, s66, 4
    s_or_b32 s88, s88, s61
    v_mov_b32 v255, s88
    s_mov_b64 exec, 1
    buffer_store_dword v255, off, s[48:51], s89 offset:128 sc1
    s_mov_b64 exec, -1
    s_mov_b32 s84, 0
    s_branch L_nopend_40
L_qslow_41:
    s_cmp_eq_u32 s66, 1
    s_cselect_b32 s88, 0, s63
    s_cmp_eq_u32 s88, 0
    s_cbranch_scc1 L_qgen_98
    buffer_load_dword v114, v14, s[48:51], 0 offen sc1
    s_nop 7
L_qfast_97:
    buffer_load_dword v113, v14, s[48:51], 0 offen sc1
    s_waitcnt vmcnt(1)
    v_cmp_ne_u32 vcc, v112, v114
    s_cbranch_vccz L_qpass_38
    buffer_load_dword v114, v14, s[48:51], 0 offen sc1
    s_waitcnt vmcnt(1)
    v_cmp_ne_u32 vcc, v112, v113
    s_cbranch_vccz L_qpass_38
    s_sub_u32 s67, s67, 1
    s_cbranch_scc1 L_end
    s_branch L_qfast_97
L_qgen_98:
    s_cmp_eq_u32 s63, 0
    s_cbranch_scc1 L_qagain_42m
    v_not_b32 v115, v15
    v_and_b32 v116, v113, v15
    v_and_b32 v115, v113, v115
    v_cmp_ne_u32 s[96:97], 0, v115
    v_cmp_eq_u32 vcc, 0, v116
    s_nop 1
    s_cmp_eq_u64 s[96:97], 0
    s_cbranch_scc1 L_qagain_42
    s_and_b32 s88, vcc_lo, vcc_hi
    s_andn2_b32 s88, 0xffff0000, s88
    s_cbranch_scc1 L_qagain_42
    s_mov_b32 s63, 0
    s_add_u32 s74, s74, 32768
    s_add_u32 s75, s75, 32768
    s_add_u32 s76, s76, 32768
    v_lshlrev_b32 v115, 11, v30
    v_add_u32 v14, v115, v14
    s_cmp_eq_u32 s59, 7
    s_cbranch_scc1 L_qagain_42
    buffer_wbl2 sc1
    s_waitcnt vmcnt(0)
    s_or_b32 s88, s61, 16
    v_mov_b32 v255, s88
    s_mov_b64 exec, 1
    buffer_store_dword v255, off, s[48:51], s74 sc1
    s_mov_b64 exec, -1
    s_branch L_qagain_42
L_qagain_42m:
    v_and_b32 v116, v113, v15
    v_cmp_ne_u32 vcc, 0, v116
    s_cbranch_vccz L_qpass_38
L_qagain_42:
    s_sub_u32 s67, s67, 1
    s_cbranch_scc1 L_end
    s_branch L_qpoll_37
L_hslow_46:
    s_sub_u32 s67, s67, 1
    s_cbranch_scc1 L_end
    buffer_load_dword v194, v252, s[48:51], 0 offen sc1
    s_waitcnt vmcnt(0)
    v_cmp_ne_u32 vcc, v195, v194
    s_cbranch_vccnz L_hslow_46
    s_branch L_hback_47
L_ofar_48:
    buffer_store_dwordx2 v[168:169], v4, s[48:51], s70 offen sc1
    buffer_store_dwordx2 v[170:171], v5, s[48:51], s70 offen sc1
    v_pk_mul_f32 v[152:153], v[152:153], v[164:165] op_sel_hi:[1,0]
    v_pk_mul_f32 v[154:155], v[154:155], v[164:165] op_sel_hi:[1,0]
    v_pk_mul_f32 v[156:157], v[156:157], v[164:165] op_sel_hi:[1,0]
    v_pk_mul_f32 v[158:159], v[158:159], v[164:165] op_sel_hi:[1,0]
    v_cvt_pk_bf16_f32 v172, v152, v153
    v_cvt_pk_bf16_f32 v173, v154, v155
    v_cvt_pk_bf16_f32 v174, v156, v157
    v_cvt_pk_bf16_f32 v175, v158, v159
    buffer_store_dwordx2 v[172:173], v4, s[48:51], s89 offen sc1
    buffer_store_dwordx2 v[174:175], v5, s[48:51], s89 offen sc1
    s_branch L_ostored_49
L_pubslow_50:
    s_waitcnt vmcnt(0)
    buffer_wbl2 sc1
    s_waitcnt vmcnt(0)
    s_mov_b64 exec, 1
    buffer_store_dword v255, off, s[48:51], s75 sc1
    s_branch L_pubdone_51
L_pend_54:
    s_lshl_b32 s89, s59, 2
    s_add_u32 s89, s89, s79
    s_lshl_b32 s88, s66, 4
    s_or_b32 s88, s88, s61
    v_mov_b32 v255, s88
    s_mov_b64 exec, 1
    buffer_store_dword v255, off, s[48:51], s89 offset:128 sc1
    s_mov_b64 exec, -1
    s_mov_b32 s84, 0
    s_branch L_nopend_55
L_qslow_56:
    s_cmp_eq_u32 s66, 1
    s_cselect_b32 s88, 0, s63
    s_cmp_eq_u32 s88, 0
    s_cbranch_scc1 L_qgen_100
    buffer_load_dword v114, v14, s[48:51], 0 offen sc1
    s_nop 7
L_qfast_99:
    buffer_load_dword v113, v14, s[48:51], 0 offen sc1
    s_waitcnt vmcnt(1)
    v_cmp_ne_u32 vcc, v112, v114
    s_cbranch_vccz L_qpass_53
    buffer_load_dword v114, v14, s[48:51], 0 offen sc1
    s_waitcnt vmcnt(1)
    v_cmp_ne_u32 vcc, v112, v113
    s_cbranch_vccz L_qpass_53
    s_sub_u32 s67, s67, 1
    s_cbranch_scc1 L_end
    s_branch L_qfast_99
L_qgen_100:
    s_cmp_eq_u32 s63, 0
    s_cbranch_scc1 L_qagain_57m
    v_not_b32 v115, v15
    v_and_b32 v116, v113, v15
    v_and_b32 v115, v113, v115
    v_cmp_ne_u32 s[96:97], 0, v115
    v_cmp_eq_u32 vcc, 0, v116
    s_nop 1
    s_cmp_eq_u64 s[96:97], 0
    s_cbranch_scc1 L_qagain_57
    s_and_b32 s88, vcc_lo, vcc_hi
    s_andn2_b32 s88, 0xffff0000, s88
    s_cbranch_scc1 L_qagain_57
    s_mov_b32 s63, 0
    s_add_u32 s74, s74, 32768
    s_add_u32 s75, s75, 32768
    s_add_u32 s76, s76, 32768
    v_lshlrev_b32 v115, 11, v30
    v_add_u32 v14, v115, v14
    s_cmp_eq_u32 s59, 7
    s_cbranch_scc1 L_qagain_57
    buffer_wbl2 sc1
    s_waitcnt vmcnt(0)
    s_or_b32 s88, s61, 16
    v_mov_b32 v255, s88
    s_mov_b64 exec, 1
    buffer_store_dword v255, off, s[48:51], s74 sc1
    s_mov_b64 exec, -1
    s_branch L_qagain_57
L_qagain_57m:
    v_and_b32 v116, v113, v15
    v_cmp_ne_u32 vcc, 0, v116
    s_cbranch_vccz L_qpass_53
L_qagain_57:
    s_sub_u32 s67, s67, 1
    s_cbranch_scc1 L_end
    s_branch L_qpoll_52
L_take_64:
    buffer_load_dwordx4 v[204:207], v247, s[48:51], s89 offen sc1
    s_branch L_kept_65
L_look_67:
    s_waitcnt vmcnt(0)
    v_xor_b32 v184, s62, v207
    v_and_b32 v184, v184, v248
    v_cmp_lt_u32 vcc, 0xffff, v184
    s_cbranch_vccnz L_miss_101
    v_mfma_f32_16x16x32_bf16 v[120:123], a[238:241], v[204:207], v[120:123]
    v_mfma_f32_16x16x32_bf16 v[124:127], a[236:239], v[204:207], v[124:127]
    s_nop 6
    v_cvt_pk_bf16_f32 v188, v120, v121
    v_cvt_pk_bf16_f32 v189, v122, v123
    v_cvt_pk_bf16_f32 v190, v124, v125
    v_cvt_pk_bf16_f32 v191, v126, v127
    v_and_b32 v191, 0xffff, v191
    v_or_b32 v191, s62, v191
    buffer_store_dwordx4 v[188:191], v247, s[48:51], s80 offen sc1
    s_mov_b32 s90, 1
    s_nop 0
    s_branch L_looked_68
L_miss_101:
    buffer_load_dwordx4 v[204:207], v247, s[48:51], s89 offen sc1
    s_branch L_looked_68
L_look_69:
    s_waitcnt vmcnt(0)
    v_xor_b32 v184, s62, v207
    v_and_b32 v184, v184, v248
    v_cmp_lt_u32 vcc, 0xffff, v184
    s_cbranch_vccnz L_miss_102
    v_mfma_f32_16x16x32_bf16 v[120:123], a[238:241], v[204:207], v[120:123]
    v_mfma_f32_16x16x32_bf16 v[124:127], a[236:239], v[204:207], v[124:127]
    s_nop 6
    v_cvt_pk_bf16_f32 v188, v120, v121
    v_cvt_pk_bf16_f32 v189, v122, v123
    v_cvt_pk_bf16_f32 v190, v124, v125
    v_cvt_pk_bf16_f32 v191, v126, v127
    v_and_b32 v191, 0xffff, v191
    v_or_b32 v191, s62, v191
    buffer_store_dwordx4 v[188:191], v247, s[48:51], s80 offen sc1
    s_mov_b32 s90, 1
    s_nop 0
    s_branch L_looked_70
L_miss_102:
    buffer_load_dwordx4 v[204:207], v247, s[48:51], s89 offen sc1
    s_branch L_looked_70
L_look_71:
    s_waitcnt vmcnt(0)
    v_xor_b32 v184, s62, v207
    v_and_b32 v184, v184, v248
    v_cmp_lt_u32 vcc, 0xffff, v184
    s_cbranch_vccnz L_miss_103
    v_mfma_f32_16x16x32_bf16 v[120:123], a[238:241], v[204:207], v[120:123]
    v_mfma_f32_16x16x32_bf16 v[124:127], a[236:239], v[204:207], v[124:127]
    s_nop 6
    v_cvt_pk_bf16_f32 v188, v120, v121
    v_cvt_pk_bf16_f32 v189, v122, v123
    v_cvt_pk_bf16_f32 v190, v124, v125
    v_cvt_pk_bf16_f32 v191, v126, v127
    v_and_b32 v191, 0xffff, v191
    v_or_b32 v191, s62, v191
    buffer_store_dwordx4 v[188:191], v247, s[48:51], s80 offen sc1
    s_mov_b32 s90, 1
    s_nop 0
    s_branch L_looked_72
L_miss_103:
    buffer_load_dwordx4 v[204:207], v247, s[48:51], s89 offen sc1
    s_branch L_looked_72
L_look_73:
    s_waitcnt vmcnt(0)
    v_xor_b32 v184, s62, v207
    v_and_b32 v184, v184, v248
    v_cmp_lt_u32 vcc, 0xffff, v184
    s_cbranch_vccnz L_miss_104
    v_mfma_f32_16x16x32_bf16 v[120:123], a[238:241], v[204:207], v[120:123]
    v_mfma_f32_16x16x32_bf16 v[124:127], a[236:239], v[204:207], v[124:127]
    s_nop 6
    v_cvt_pk_bf16_f32 v188, v120, v121
    v_cvt_pk_bf16_f32 v189, v122, v123
    v_cvt_pk_bf16_f32 v190, v124, v125
    v_cvt_pk_bf16_f32 v191, v126, v127
    v_and_b32 v191, 0xffff, v191
    v_or_b32 v191, s62, v191
    buffer_store_dwordx4 v[188:191], v247, s[48:51], s80 offen sc1
    s_mov_b32 s90, 1
    s_nop 0
    s_branch L_looked_74
L_miss_104:
    buffer_load_dwordx4 v[204:207], v247, s[48:51], s89 offen sc1
    s_branch L_looked_74
L_look_75:
    s_waitcnt vmcnt(0)
    v_xor_b32 v184, s62, v207
    v_and_b32 v184, v184, v248
    v_cmp_lt_u32 vcc, 0xffff, v184
    s_cbranch_vccnz L_miss_105
    v_mfma_f32_16x16x32_bf16 v[120:123], a[238:241], v[204:207], v[120:123]
    v_mfma_f32_16x16x32_bf16 v[124:127], a[236:239], v[204:207], v[124:127]
    s_nop 6
    v_cvt_pk_bf16_f32 v188, v120, v121
    v_cvt_pk_bf16_f32 v189, v122, v123
    v_cvt_pk_bf16_f32 v190, v124, v125
    v_cvt_pk_bf16_f32 v191, v126, v127
    v_and_b32 v191, 0xffff, v191
    v_or_b32 v191, s62, v191
    buffer_store_dwordx4 v[188:191], v247, s[48:51], s80 offen sc1
    s_mov_b32 s90, 1
    s_nop 0
    s_branch L_looked_76
L_miss_105:
    buffer_load_dwordx4 v[204:207], v247, s[48:51], s89 offen sc1
    s_branch L_looked_76
L_look_77:
    s_waitcnt vmcnt(0)
    v_xor_b32 v184, s62, v207
    v_and_b32 v184, v184, v248
    v_cmp_lt_u32 vcc, 0xffff, v184
    s_cbranch_vccnz L_miss_106
    v_mfma_f32_16x16x32_bf16 v[120:123], a[238:241], v[204:207], v[120:123]
    v_mfma_f32_16x16x32_bf16 v[124:127], a[236:239], v[204:207], v[124:127]
    s_nop 6
    v_cvt_pk_bf16_f32 v188, v120, v121
    v_cvt_pk_bf16_f32 v189, v122, v123
    v_cvt_pk_bf16_f32 v190, v124, v125
    v_cvt_pk_bf16_f32 v191, v126, v127
    v_and_b32 v191, 0xffff, v191
    v_or_b32 v191, s62, v191
    buffer_store_dwordx4 v[188:191], v247, s[48:51], s80 offen sc1
    s_mov_b32 s90, 1
    s_nop 0
    s_branch L_looked_78
L_miss_106:
    buffer_load_dwordx4 v[204:207], v247, s[48:51], s89 offen sc1
    s_branch L_looked_78
L_look_79:
    s_waitcnt vmcnt(0)
    v_xor_b32 v184, s62, v207
    v_and_b32 v184, v184, v248
    v_cmp_lt_u32 vcc, 0xffff, v184
    s_cbranch_vccnz L_miss_107
    v_mfma_f32_16x16x32_bf16 v[120:123], a[238:241], v[204:207], v[120:123]
    v_mfma_f32_16x16x32_bf16 v[124:127], a[236:239], v[204:207], v[124:127]
    s_nop 6
    v_cvt_pk_bf16_f32 v188, v120, v121
    v_cvt_pk_bf16_f32 v189, v122, v123
    v_cvt_pk_bf16_f32 v190, v124, v125
    v_cvt_pk_bf16_f32 v191, v126, v127
    v_and_b32 v191, 0xffff, v191
    v_or_b32 v191, s62, v191
    buffer_store_dwordx4 v[188:191], v247, s[48:51], s80 offen sc1
    s_mov_b32 s90, 1
    s_nop 0
    s_branch L_looked_80
L_miss_107:
    s_sub_u32 s67, s67, 1
    s_cbranch_scc1 L_end
    buffer_load_dwordx4 v[204:207], v247, s[48:51], s89 offen sc1
    s_branch L_look_79
L_give_62:
    s_nop 7
    v_cvt_pk_bf16_f32 v188, v120, v121
    v_cvt_pk_bf16_f32 v189, v122, v123
    v_cvt_pk_bf16_f32 v190, v124, v125
    v_cvt_pk_bf16_f32 v191, v126, v127
    v_and_b32 v191, 0xffff, v191
    v_or_b32 v191, s62, v191
    s_cmp_eq_u32 s63, 0
    s_cbranch_scc1 L_givefar_66
    buffer_store_dwordx4 v[188:191], v247, s[48:51], s89 offen
    s_branch L_kept_65
L_givefar_66:
    buffer_store_dwordx4 v[188:191], v247, s[48:51], s89 offen sc1
    s_branch L_kept_65
L_gslow_83:
    s_sub_u32 s67, s67, 1
    s_cbranch_scc1 L_end
    buffer_load_dwordx4 a[0:3], v247, s[48:51], s8 offen sc1
    buffer_load_dwordx4 a[4:7], v247, s[48:51], s9 offen sc1
    buffer_load_dwordx4 a[8:11], v247, s[48:51], s10 offen sc1
    buffer_load_dwordx4 a[12:15], v247, s[48:51], s11 offen sc1
    buffer_load_dwordx4 a[16:19], v247, s[48:51], s12 offen sc1
    buffer_load_dwordx4 a[20:23], v247, s[48:51], s13 offen sc1
    buffer_load_dwordx4 a[24:27], v247, s[48:51], s14 offen sc1
    buffer_load_dwordx4 a[28:31], v247, s[48:51], s15 offen sc1
    s_branch L_ggo_82
L_ofar_85:
    buffer_store_dwordx2 v[116:117], v4, s[48:51], s70 offen sc1
    buffer_store_dwordx2 v[118:119], v5, s[48:51], s70 offen sc1
    v_pk_mul_f32 v[152:153], v[152:153], v[164:165] op_sel_hi:[1,0]
    v_pk_mul_f32 v[154:155], v[154:155], v[164:165] op_sel_hi:[1,0]
    v_pk_mul_f32 v[156:157], v[156:157], v[164:165] op_sel_hi:[1,0]
    v_pk_mul_f32 v[158:159], v[158:159], v[164:165] op_sel_hi:[1,0]
    v_cvt_pk_bf16_f32 v120, v152, v153
    v_cvt_pk_bf16_f32 v121, v154, v155
    v_cvt_pk_bf16_f32 v122, v156, v157
    v_cvt_pk_bf16_f32 v123, v158, v159
    buffer_store_dwordx2 v[120:121], v4, s[48:51], s89 offen sc1
    buffer_store_dwordx2 v[122:123], v5, s[48:51], s89 offen sc1
    s_branch L_ostored_86
L_pubslow_88:
    s_waitcnt vmcnt(0)
    buffer_wbl2 sc1
    s_waitcnt vmcnt(0)
    s_mov_b64 exec, 1
    buffer_store_dword v255, off, s[48:51], s75 sc1
    s_branch L_pubdone_89
L_end:
    s_endpgm
.section .rodata,"a"
.p2align 6
.amdhsa_kernel interleave_layers__sliding_local_dilated__linear_kernel_hedgehog__prompt_kernel
  .amdhsa_next_free_vgpr 512
  .amdhsa_next_free_sgpr 102
  .amdhsa_accum_offset 256
  .amdhsa_group_segment_fixed_size 0
  .amdhsa_kernarg_size 80
  .amdhsa_user_sgpr_count 2
  .amdhsa_user_sgpr_kernarg_segment_ptr 1
  .amdhsa_system_sgpr_workgroup_id_x 1
.end_amdhsa_kernel
```
